```python
import torch

def _softmax(x, axis=-1):
    return torch.softmax(x, dim=axis)
def _gelu(x):
    return torch.nn.functional.gelu(x, approximate="tanh")
def _silu(x):
    return torch.nn.functional.silu(x)
def _sigmoid(x):
    return torch.sigmoid(x)
def _layernorm(x, axis=-1, eps=1e-5):
    m = x.mean(dim=axis, keepdim=True)
    v = x.var(dim=axis, keepdim=True, unbiased=False)
    return (x - m) / torch.sqrt(v + eps)
def _scatter_add(tgt, idx, src, axis=0):
    return tgt.clone().index_add_(axis, idx, src)
def _segment_sum(src, seg, n):
    out = torch.zeros((n,) + src.shape[1:], dtype=src.dtype)
    return out.index_add_(0, seg, src)
def _pad(x, pw):
    flat = tuple(v for pair in reversed(pw) for v in pair)
    return torch.nn.functional.pad(x, flat)

kernel_name = 'gated_mix__mha_block__ssm_conv_s5__prompt'

def setup_inputs():

    _w = (lambda a: (lambda t: t.to(torch.bfloat16) if t.is_floating_point() else t)(torch.as_tensor(a)))
    def _A_setup():
        B, S, D, H = 1, 2048, 512, 32
        return {
            "x": _w((lambda *s: torch.randn(*s, dtype=torch.bfloat16) * 0.05)(B, S, D)),
            "wqkv": _w((lambda *s: torch.randn(*s, dtype=torch.bfloat16) * 0.8)(D, 3 * D)),
            "wo": _w((lambda *s: torch.randn(*s, dtype=torch.bfloat16) * 0.05)(D, D)),
        }
    _A_in = _A_setup()

    def _B_setup():
        B, S, D = 1, 2048, 512
        P = D
        Lambda_re = -0.5 * (lambda _x: torch.exp(torch.as_tensor(_x)))((lambda *s: torch.randn(*s, dtype=torch.bfloat16) * 0.4)(P))
        Lambda_im = (lambda *s: torch.randn(*s, dtype=torch.bfloat16) * 0.8)(P) * 1.0
        B_re = (lambda *s: torch.randn(*s, dtype=torch.bfloat16) * 0.8)(P, D) * (D ** -0.5)
        B_im = (lambda *s: torch.randn(*s, dtype=torch.bfloat16) * 0.8)(P, D) * (D ** -0.5)
        C_re = (lambda *s: torch.randn(*s, dtype=torch.bfloat16) * 0.8)(D, P) * (P ** -0.5)
        C_im = (lambda *s: torch.randn(*s, dtype=torch.bfloat16) * 0.8)(D, P) * (P ** -0.5)
        log_dt = (lambda *s: torch.randn(*s, dtype=torch.bfloat16) * 0.4)(P) * 0.3 - 2.0
        Dskip = (lambda *s: torch.randn(*s, dtype=torch.bfloat16) * 0.1)(D)
        return {
            "x": _w((lambda *s: torch.randn(*s, dtype=torch.bfloat16) * 0.05)(B, S, D)),
            "Lambda_re": _w(Lambda_re),
            "Lambda_im": _w(Lambda_im),
            "B_re": _w(B_re),
            "B_im": _w(B_im),
            "C_re": _w(C_re),
            "C_im": _w(C_im),
            "log_dt": _w(log_dt),
            "Dskip": _w(Dskip),
        }
    _B_in = _B_setup()

    return {
        "A_x": _A_in["x"],
        "A_wqkv": _A_in["wqkv"],
        "A_wo": _A_in["wo"],
        "B_x": _B_in["x"],
        "B_Lambda_re": _B_in["Lambda_re"],
        "B_Lambda_im": _B_in["Lambda_im"],
        "B_B_re": _B_in["B_re"],
        "B_B_im": _B_in["B_im"],
        "B_C_re": _B_in["C_re"],
        "B_C_im": _B_in["C_im"],
        "B_log_dt": _B_in["log_dt"],
        "B_Dskip": _B_in["Dskip"],
        "gate_w": _w((lambda *s: torch.randn(*s, dtype=torch.bfloat16) * 0.05)(512) * 16.0),
    }

def reference(A_x, A_wqkv, A_wo, B_x, B_Lambda_re, B_Lambda_im, B_B_re, B_B_im, B_C_re, B_C_im, B_log_dt, B_Dskip, gate_w):
    def _A_ref(x, wqkv, wo):
        B, S, D = x.shape
        H = 32
        Dh = D // H
        qkv = (lambda x, *d: x.permute(*d))((x @ wqkv).reshape(B, S, 3, H, Dh), 2, 0, 3, 1, 4)
        q, k, v = qkv[0], qkv[1], qkv[2]
        scores = torch.einsum("bhqd,bhkd->bhqk", q, k) * (Dh ** -0.5)
        p = _softmax(scores, axis=-1)
        o = torch.einsum("bhqk,bhkd->bhqd", p, v)
        return (lambda x, *d: x.permute(*d))(o, 0, 2, 1, 3).reshape(B, S, D) @ wo

    def _B_ref(x, Lambda_re, Lambda_im, B_re, B_im, C_re, C_im, log_dt, Dskip):
        Bsz, L, H = x.shape
        Lam = Lambda_re + 1j * Lambda_im
        Bmat = B_re + 1j * B_im
        Cmat = C_re + 1j * C_im
        dt = torch.exp(log_dt)
        Lam_bar = torch.exp(dt * Lam)
        B_bar = ((Lam_bar - 1.0) / Lam)[:, None] * Bmat
        Bu = torch.einsum("bld,pd->blp", x + 0j, B_bar)
        h = torch.zeros_like(Bu[:, 0, :])
        hs = []
        for t in range(L):
            h = Lam_bar[None, :] * h + Bu[:, t, :]
            hs.append(h)
        hseq = torch.stack(hs, 1)
        y = 2.0 * torch.einsum("blp,dp->bld", hseq, Cmat).real + x * Dskip[None, None, :]
        return y

    x = A_x
    g = _sigmoid((x * gate_w).sum(-1, keepdims=True))
    a = _A_ref(x, A_wqkv, A_wo)
    b = _B_ref(x, B_Lambda_re, B_Lambda_im, B_B_re, B_B_im, B_C_re, B_C_im, B_log_dt, B_Dskip)
    return g * a + (1 - g) * b
```

```asm
; @launch kernel=k1_kernel grid=(256,1,1) block=(768,1,1) lds=131072
; @launch kernel=k2_kernel grid=(256,1,1) block=(768,1,1) lds=157760
.amdgcn_target "amdgcn-amd-amdhsa--gfx950"
.text
.globl k1_kernel
.p2align 8
.type k1_kernel,@function
k1_kernel:
    s_cmp_ge_u32 s2, 256
    s_cbranch_scc1 L_k1_end
    s_load_dwordx4 s[4:7], s[0:1], 0
    s_load_dwordx8 s[8:15], s[0:1], 32
    s_load_dwordx2 s[16:17], s[0:1], 80
    s_load_dwordx2 s[18:19], s[0:1], 96
    s_load_dwordx2 s[20:21], s[0:1], 120
    s_load_dwordx4 s[60:63], s[0:1], 64
    s_load_dwordx2 s[64:65], s[0:1], 16
    v_lshrrev_b32 v2, 6, v0
    v_and_b32 v1, 63, v0
    s_and_b32 s23, s2, 7
    v_readfirstlane_b32 s22, v2
    s_lshr_b32 s24, s2, 3
    s_lshr_b32 s27, s24, 4
    s_and_b32 s26, s23, 1
    s_lshl_b32 s26, s26, 3
    s_and_b32 s49, s24, 7
    s_add_u32 s26, s26, s49
    s_lshr_b32 s3, s23, 1
    s_lshl_b32 s3, s3, 1
    s_bfe_u32 s49, s24, 0x10003
    s_add_u32 s3, s3, s49
    s_add_u32 s22, s22, 8
    s_cmp_ge_u32 s22, 12
    s_cselect_b32 s49, 12, 0
    s_sub_u32 s22, s22, s49
    s_add_u32 s49, s27, 1
    s_lshr_b32 s49, s22, s49
    s_and_b32 s49, s49, 1
    s_lshl_b32 s25, s3, 1
    s_add_u32 s25, s25, s49
    s_cmp_lt_u32 s22, 8
    s_cbranch_scc1 L_k1_compute
    s_sub_u32 s50, s22, 8
    v_lshrrev_b32 v3, 5, v1
    v_lshlrev_b32 v3, 4, v3
    v_bfe_u32 v4, v1, 3, 2
    v_add_u32 v3, v3, v4
    s_lshl_b32 s49, s26, 2
    s_add_u32 s49, s49, s50
    s_lshl_b32 s49, s49, 5
    v_add_u32 v3, s49, v3
    v_bfe_u32 v4, v1, 4, 2
    v_and_b32 v5, 7, v1
    v_xor_b32 v4, v4, v5
    v_lshlrev_b32 v4, 4, v4
    v_lshl_add_u32 v7, v3, 10, v4
    v_xor_b32 v8, 64, v7
    s_lshl_b32 s51, s50, 12
    s_mov_b32 s45, 0
    s_lshl_b32 s55, s3, 2
    s_add_u32 s55, s55, s26
    s_lshl_b32 s49, s27, 1
    s_add_u32 s55, s55, s49
    s_and_b32 s55, s55, 7
    s_cmp_eq_u32 s27, 0
    s_cbranch_scc0 L_k1_ldB
    v_lshrrev_b32 v3, 3, v1
    s_lshl_b32 s49, s50, 4
    v_add_u32 v3, s49, v3
    v_mul_u32_u24 v3, 3072, v3
    v_bfe_u32 v4, v1, 4, 1
    v_lshlrev_b32 v4, 2, v4
    v_and_b32 v5, 7, v1
    v_xor_b32 v4, v4, v5
    v_lshl_add_u32 v3, v4, 4, v3
    s_lshl_b32 s49, s3, 7
    v_add_u32 v9, s49, v3
    s_lshl_b32 s52, s50, 11
    s_waitcnt lgkmcnt(0)
    s_mov_b32 s28, s4
    s_and_b32 s29, s5, 0xffff
    s_mov_b32 s30, 0x200000
    s_mov_b32 s31, 0x20000
    s_mov_b32 s32, s6
    s_and_b32 s33, s7, 0xffff
    s_mov_b32 s34, 0x180000
    s_mov_b32 s35, 0x20000
    s_cmp_eq_u32 s2, 0
    s_cselect_b32 s49, s22, 0
    s_cmp_eq_u32 s49, 8
    s_cbranch_scc0 L_k1_nocnt
    v_lshlrev_b32 v3, 8, v1
    v_add_u32 v3, 18874368, v3
    v_mov_b32 v4, 0
    global_store_dword v3, v4, s[20:21] sc0 sc1
    v_add_u32 v3, 16384, v3
    v_cmp_gt_u32 vcc, 16, v1
    s_and_saveexec_b64 s[56:57], vcc
    global_store_dword v3, v4, s[20:21] sc0 sc1
    s_mov_b64 exec, s[56:57]
L_k1_nocnt:
    s_lshl_b32 s46, s55, 7
    s_mul_i32 s47, s55, 196608
    s_add_u32 s60, s45, s51
    s_add_u32 s61, s45, s52
    s_add_u32 s55, s55, 1
    s_and_b32 s55, s55, 7
    s_add_u32 s45, s45, 40960
    s_cmp_eq_u32 s45, 122880
    s_cselect_b32 s45, 0, s45
    s_add_u32 m0, s60, 0
    s_add_u32 s50, s46, 0
    buffer_load_dwordx4 v7, s[28:31], s50 offen lds
    s_add_u32 m0, s60, 1024
    s_add_u32 s50, s46, 4096
    buffer_load_dwordx4 v8, s[28:31], s50 offen lds
    s_add_u32 m0, s60, 2048
    s_add_u32 s50, s46, 8192
    buffer_load_dwordx4 v7, s[28:31], s50 offen lds
    s_add_u32 m0, s60, 3072
    s_add_u32 s50, s46, 12288
    buffer_load_dwordx4 v8, s[28:31], s50 offen lds
    s_add_u32 m0, s61, 16384
    s_add_u32 s50, s47, 0
    buffer_load_dwordx4 v9, s[32:35], s50 offen lds
    s_add_u32 m0, s61, 17408
    s_add_u32 s50, s47, 24576
    buffer_load_dwordx4 v9, s[32:35], s50 offen lds
    s_add_u32 m0, s61, 24576
    s_add_u32 s50, s47, 1024
    buffer_load_dwordx4 v9, s[32:35], s50 offen lds
    s_add_u32 m0, s61, 25600
    s_add_u32 s50, s47, 25600
    buffer_load_dwordx4 v9, s[32:35], s50 offen lds
    s_add_u32 m0, s61, 32768
    s_add_u32 s50, s47, 2048
    buffer_load_dwordx4 v9, s[32:35], s50 offen lds
    s_add_u32 m0, s61, 33792
    s_add_u32 s50, s47, 26624
    buffer_load_dwordx4 v9, s[32:35], s50 offen lds
    s_lshl_b32 s46, s55, 7
    s_mul_i32 s47, s55, 196608
    s_add_u32 s60, s45, s51
    s_add_u32 s61, s45, s52
    s_add_u32 s55, s55, 1
    s_and_b32 s55, s55, 7
    s_add_u32 s45, s45, 40960
    s_cmp_eq_u32 s45, 122880
    s_cselect_b32 s45, 0, s45
    s_add_u32 m0, s60, 0
    s_add_u32 s50, s46, 0
    buffer_load_dwordx4 v7, s[28:31], s50 offen lds
    s_add_u32 m0, s60, 1024
    s_add_u32 s50, s46, 4096
    buffer_load_dwordx4 v8, s[28:31], s50 offen lds
    s_add_u32 m0, s60, 2048
    s_add_u32 s50, s46, 8192
    buffer_load_dwordx4 v7, s[28:31], s50 offen lds
    s_add_u32 m0, s60, 3072
    s_add_u32 s50, s46, 12288
    buffer_load_dwordx4 v8, s[28:31], s50 offen lds
    s_add_u32 m0, s61, 16384
    s_add_u32 s50, s47, 0
    buffer_load_dwordx4 v9, s[32:35], s50 offen lds
    s_add_u32 m0, s61, 17408
    s_add_u32 s50, s47, 24576
    buffer_load_dwordx4 v9, s[32:35], s50 offen lds
    s_add_u32 m0, s61, 24576
    s_add_u32 s50, s47, 1024
    buffer_load_dwordx4 v9, s[32:35], s50 offen lds
    s_add_u32 m0, s61, 25600
    s_add_u32 s50, s47, 25600
    buffer_load_dwordx4 v9, s[32:35], s50 offen lds
    s_add_u32 m0, s61, 32768
    s_add_u32 s50, s47, 2048
    buffer_load_dwordx4 v9, s[32:35], s50 offen lds
    s_add_u32 m0, s61, 33792
    s_add_u32 s50, s47, 26624
    buffer_load_dwordx4 v9, s[32:35], s50 offen lds
    s_waitcnt vmcnt(10)
    s_barrier
    s_mov_b32 s44, 1
L_k1_l0_loop:
    s_lshl_b32 s46, s55, 7
    s_mul_i32 s47, s55, 196608
    s_add_u32 s60, s45, s51
    s_add_u32 s61, s45, s52
    s_add_u32 s55, s55, 1
    s_and_b32 s55, s55, 7
    s_add_u32 s45, s45, 40960
    s_cmp_eq_u32 s45, 122880
    s_cselect_b32 s45, 0, s45
    s_add_u32 m0, s60, 0
    s_add_u32 s50, s46, 0
    buffer_load_dwordx4 v7, s[28:31], s50 offen lds
    s_add_u32 m0, s60, 1024
    s_add_u32 s50, s46, 4096
    buffer_load_dwordx4 v8, s[28:31], s50 offen lds
    s_add_u32 m0, s60, 2048
    s_add_u32 s50, s46, 8192
    buffer_load_dwordx4 v7, s[28:31], s50 offen lds
    s_add_u32 m0, s60, 3072
    s_add_u32 s50, s46, 12288
    buffer_load_dwordx4 v8, s[28:31], s50 offen lds
    s_add_u32 m0, s61, 16384
    s_add_u32 s50, s47, 0
    buffer_load_dwordx4 v9, s[32:35], s50 offen lds
    s_add_u32 m0, s61, 17408
    s_add_u32 s50, s47, 24576
    buffer_load_dwordx4 v9, s[32:35], s50 offen lds
    s_add_u32 m0, s61, 24576
    s_add_u32 s50, s47, 1024
    buffer_load_dwordx4 v9, s[32:35], s50 offen lds
    s_add_u32 m0, s61, 25600
    s_add_u32 s50, s47, 25600
    buffer_load_dwordx4 v9, s[32:35], s50 offen lds
    s_add_u32 m0, s61, 32768
    s_add_u32 s50, s47, 2048
    buffer_load_dwordx4 v9, s[32:35], s50 offen lds
    s_add_u32 m0, s61, 33792
    s_add_u32 s50, s47, 26624
    buffer_load_dwordx4 v9, s[32:35], s50 offen lds
    s_waitcnt vmcnt(10)
    s_barrier
    s_add_u32 s44, s44, 1
    s_cmp_lt_u32 s44, 7
    s_cbranch_scc1 L_k1_l0_loop
    s_waitcnt vmcnt(0)
    s_barrier
    s_endpgm
L_k1_ldB:
    v_lshrrev_b32 v3, 3, v1
    s_lshl_b32 s49, s50, 3
    v_add_u32 v3, s49, v3
    v_bfe_u32 v4, v3, 1, 3
    v_and_b32 v5, 7, v1
    v_xor_b32 v4, v4, v5
    v_lshlrev_b32 v4, 4, v4
    s_lshl_b32 s49, s3, 6
    v_add_u32 v3, s49, v3
    v_lshl_add_u32 v9, v3, 10, v4
    s_lshl_b32 s52, s50, 10
    s_waitcnt lgkmcnt(0)
    s_mov_b32 s28, s4
    s_and_b32 s29, s5, 0xffff
    s_mov_b32 s30, 0x200000
    s_mov_b32 s31, 0x20000
    s_mov_b32 s36, s12
    s_and_b32 s37, s13, 0xffff
    s_mov_b32 s38, 0x80000
    s_mov_b32 s39, 0x20000
    s_mov_b32 s40, s14
    s_and_b32 s41, s15, 0xffff
    s_mov_b32 s42, 0x80000
    s_mov_b32 s43, 0x20000
    s_lshl_b32 s46, s55, 7
    s_mul_i32 s47, s55, 196608
    s_add_u32 s60, s45, s51
    s_add_u32 s61, s45, s52
    s_add_u32 s55, s55, 1
    s_and_b32 s55, s55, 7
    s_add_u32 s45, s45, 40960
    s_cmp_eq_u32 s45, 122880
    s_cselect_b32 s45, 0, s45
    s_add_u32 m0, s60, 0
    s_add_u32 s50, s46, 0
    buffer_load_dwordx4 v7, s[28:31], s50 offen lds
    s_add_u32 m0, s60, 1024
    s_add_u32 s50, s46, 4096
    buffer_load_dwordx4 v8, s[28:31], s50 offen lds
    s_add_u32 m0, s60, 2048
    s_add_u32 s50, s46, 8192
    buffer_load_dwordx4 v7, s[28:31], s50 offen lds
    s_add_u32 m0, s60, 3072
    s_add_u32 s50, s46, 12288
    buffer_load_dwordx4 v8, s[28:31], s50 offen lds
    s_add_u32 m0, s61, 16384
    s_add_u32 s50, s46, 0
    buffer_load_dwordx4 v9, s[36:39], s50 offen lds
    s_add_u32 m0, s61, 20480
    s_add_u32 s50, s46, 0
    buffer_load_dwordx4 v9, s[40:43], s50 offen lds
    s_add_u32 m0, s61, 24576
    s_add_u32 s50, s46, 32768
    buffer_load_dwordx4 v9, s[36:39], s50 offen lds
    s_add_u32 m0, s61, 28672
    s_add_u32 s50, s46, 32768
    buffer_load_dwordx4 v9, s[40:43], s50 offen lds
    s_lshl_b32 s46, s55, 7
    s_mul_i32 s47, s55, 196608
    s_add_u32 s60, s45, s51
    s_add_u32 s61, s45, s52
    s_add_u32 s55, s55, 1
    s_and_b32 s55, s55, 7
    s_add_u32 s45, s45, 40960
    s_cmp_eq_u32 s45, 122880
    s_cselect_b32 s45, 0, s45
    s_add_u32 m0, s60, 0
    s_add_u32 s50, s46, 0
    buffer_load_dwordx4 v7, s[28:31], s50 offen lds
    s_add_u32 m0, s60, 1024
    s_add_u32 s50, s46, 4096
    buffer_load_dwordx4 v8, s[28:31], s50 offen lds
    s_add_u32 m0, s60, 2048
    s_add_u32 s50, s46, 8192
    buffer_load_dwordx4 v7, s[28:31], s50 offen lds
    s_add_u32 m0, s60, 3072
    s_add_u32 s50, s46, 12288
    buffer_load_dwordx4 v8, s[28:31], s50 offen lds
    s_add_u32 m0, s61, 16384
    s_add_u32 s50, s46, 0
    buffer_load_dwordx4 v9, s[36:39], s50 offen lds
    s_add_u32 m0, s61, 20480
    s_add_u32 s50, s46, 0
    buffer_load_dwordx4 v9, s[40:43], s50 offen lds
    s_add_u32 m0, s61, 24576
    s_add_u32 s50, s46, 32768
    buffer_load_dwordx4 v9, s[36:39], s50 offen lds
    s_add_u32 m0, s61, 28672
    s_add_u32 s50, s46, 32768
    buffer_load_dwordx4 v9, s[40:43], s50 offen lds
    s_waitcnt vmcnt(8)
    s_barrier
    s_mov_b32 s44, 1
L_k1_l1_loop:
    s_lshl_b32 s46, s55, 7
    s_mul_i32 s47, s55, 196608
    s_add_u32 s60, s45, s51
    s_add_u32 s61, s45, s52
    s_add_u32 s55, s55, 1
    s_and_b32 s55, s55, 7
    s_add_u32 s45, s45, 40960
    s_cmp_eq_u32 s45, 122880
    s_cselect_b32 s45, 0, s45
    s_add_u32 m0, s60, 0
    s_add_u32 s50, s46, 0
    buffer_load_dwordx4 v7, s[28:31], s50 offen lds
    s_add_u32 m0, s60, 1024
    s_add_u32 s50, s46, 4096
    buffer_load_dwordx4 v8, s[28:31], s50 offen lds
    s_add_u32 m0, s60, 2048
    s_add_u32 s50, s46, 8192
    buffer_load_dwordx4 v7, s[28:31], s50 offen lds
    s_add_u32 m0, s60, 3072
    s_add_u32 s50, s46, 12288
    buffer_load_dwordx4 v8, s[28:31], s50 offen lds
    s_add_u32 m0, s61, 16384
    s_add_u32 s50, s46, 0
    buffer_load_dwordx4 v9, s[36:39], s50 offen lds
    s_add_u32 m0, s61, 20480
    s_add_u32 s50, s46, 0
    buffer_load_dwordx4 v9, s[40:43], s50 offen lds
    s_add_u32 m0, s61, 24576
    s_add_u32 s50, s46, 32768
    buffer_load_dwordx4 v9, s[36:39], s50 offen lds
    s_add_u32 m0, s61, 28672
    s_add_u32 s50, s46, 32768
    buffer_load_dwordx4 v9, s[40:43], s50 offen lds
    s_waitcnt vmcnt(8)
    s_barrier
    s_add_u32 s44, s44, 1
    s_cmp_lt_u32 s44, 7
    s_cbranch_scc1 L_k1_l1_loop
    s_waitcnt vmcnt(0)
    s_barrier
    s_endpgm
L_k1_compute:
    s_setprio 3
    s_cmp_eq_u32 s27, 0
    s_cselect_b32 s49, 4, 0
    s_cmp_lt_u32 s22, s49
    s_cbranch_scc1 L_k1_qkv0
    s_lshl_b32 s54, s26, 7
    s_lshl_b32 s49, s3, 3
    s_add_u32 s54, s54, s49
    s_add_u32 s54, s54, s22
    s_cmp_eq_u32 s27, 0
    s_cselect_b32 s49, 60, 0
    s_add_u32 s54, s54, s49
    s_lshl_b32 s49, s54, 10
    v_lshlrev_b32 v3, 4, v1
    v_add_u32 v4, s49, v3
    v_and_b32 v5, 31, v1
    s_lshl_b32 s49, s25, 5
    v_add_u32 v5, s49, v5
    v_lshlrev_b32 v5, 1, v5
    s_waitcnt lgkmcnt(0)
    global_load_dwordx4 v[8:11], v4, s[4:5]
    global_load_dwordx4 v[16:19], v3, s[18:19]
    s_cmp_eq_u32 s27, 0
    s_cbranch_scc0 L_k1_ssmld
    v_add_u32 v4, 4096, v4
    global_load_dwordx4 v[12:15], v4, s[4:5]
    s_lshl_b32 s56, s26, 3
    s_add_u32 s56, s56, s3
    s_lshl_b32 s57, s56, 2
    s_add_u32 s57, s57, s22
    s_sub_u32 s57, s57, 4
    s_mov_b32 s32, s64
    s_and_b32 s33, s65, 0xffff
    s_mov_b32 s34, 0x80000
    s_mov_b32 s35, 0x20000
    v_lshrrev_b32 v3, 2, v1
    v_lshlrev_b32 v3, 10, v3
    v_and_b32 v4, 3, v1
    v_lshl_add_u32 v3, v4, 4, v3
    s_and_b32 s49, s57, 31
    s_lshl_b32 s49, s49, 14
    s_lshr_b32 s50, s57, 5
    s_lshl_b32 s50, s50, 6
    s_add_u32 s49, s49, s50
    s_sub_u32 s50, s22, 4
    s_lshl_b32 s50, s50, 10
    s_add_u32 s55, s50, 126976
    s_mov_b32 m0, s55
    s_nop 0
    buffer_load_dwordx4 v3, s[32:35], s49 offen lds
    s_lshl_b32 s54, s57, 10
    s_add_u32 s53, s54, 19398656
    s_lshl_b32 s49, s26, 7
    s_lshl_b32 s50, s3, 3
    s_add_u32 s54, s49, s50
    s_add_u32 s54, s54, s22
    s_add_u32 s54, s54, 60
    s_barrier
    s_waitcnt vmcnt(0)
    v_mov_b32 v34, 0
    v_lshlrev_b32 v35, 16, v8
    v_lshlrev_b32 v37, 16, v16
    v_and_b32 v36, 0xffff0000, v8
    v_and_b32 v33, 0xffff0000, v16
    v_mul_f32 v32, v35, v37
    v_mul_f32 v33, v36, v33
    v_cvt_pk_bf16_f32 v32, v32, v33
    v_lshlrev_b32 v33, 16, v32
    v_and_b32 v32, 0xffff0000, v32
    v_add_f32 v34, v34, v33
    v_add_f32 v34, v34, v32
    v_lshlrev_b32 v35, 16, v9
    v_lshlrev_b32 v37, 16, v17
    v_and_b32 v36, 0xffff0000, v9
    v_and_b32 v33, 0xffff0000, v17
    v_mul_f32 v32, v35, v37
    v_mul_f32 v33, v36, v33
    v_cvt_pk_bf16_f32 v32, v32, v33
    v_lshlrev_b32 v33, 16, v32
    v_and_b32 v32, 0xffff0000, v32
    v_add_f32 v34, v34, v33
    v_add_f32 v34, v34, v32
    v_lshlrev_b32 v35, 16, v10
    v_lshlrev_b32 v37, 16, v18
    v_and_b32 v36, 0xffff0000, v10
    v_and_b32 v33, 0xffff0000, v18
    v_mul_f32 v32, v35, v37
    v_mul_f32 v33, v36, v33
    v_cvt_pk_bf16_f32 v32, v32, v33
    v_lshlrev_b32 v33, 16, v32
    v_and_b32 v32, 0xffff0000, v32
    v_add_f32 v34, v34, v33
    v_add_f32 v34, v34, v32
    v_lshlrev_b32 v35, 16, v11
    v_lshlrev_b32 v37, 16, v19
    v_and_b32 v36, 0xffff0000, v11
    v_and_b32 v33, 0xffff0000, v19
    v_mul_f32 v32, v35, v37
    v_mul_f32 v33, v36, v33
    v_cvt_pk_bf16_f32 v32, v32, v33
    v_lshlrev_b32 v33, 16, v32
    v_and_b32 v32, 0xffff0000, v32
    v_add_f32 v34, v34, v33
    v_add_f32 v34, v34, v32
    s_nop 1
    v_add_f32_dpp v34, v34, v34 row_ror:8 row_mask:0xf bank_mask:0xf
    s_nop 1
    v_add_f32_dpp v34, v34, v34 row_ror:4 row_mask:0xf bank_mask:0xf
    s_nop 1
    v_add_f32_dpp v34, v34, v34 row_ror:2 row_mask:0xf bank_mask:0xf
    s_nop 1
    v_add_f32_dpp v34, v34, v34 row_ror:1 row_mask:0xf bank_mask:0xf
    s_nop 1
    v_readlane_b32 s49, v34, 0
    v_readlane_b32 s50, v34, 16
    v_readlane_b32 s56, v34, 32
    v_readlane_b32 s57, v34, 48
    s_nop 1
    v_mov_b32 v34, s49
    v_add_f32 v34, s50, v34
    v_add_f32 v34, s56, v34
    v_add_f32 v34, s57, v34
    v_cvt_pk_bf16_f32 v34, v34, v34
    v_and_b32 v34, 0xffff0000, v34
    v_mul_f32 v34, 0xbfb8aa3b, v34
    v_exp_f32 v34, v34
    s_nop 0
    v_add_f32 v34, 1.0, v34
    v_rcp_f32 v34, v34
    s_nop 0
    v_cvt_pk_bf16_f32 v34, v34, v34
    v_and_b32 v32, 0xffff0000, v34
    v_sub_f32 v33, 1.0, v32
    v_cvt_pk_bf16_f32 v33, v33, v33
    v_and_b32 v33, 0xffff0000, v33
    s_lshl_b32 s49, s54, 3
    s_add_u32 s49, s49, 11091968
    v_mov_b32 v35, s49
    v_cmp_eq_u32 vcc, 0, v1
    s_and_saveexec_b64 s[56:57], vcc
    global_store_dwordx2 v35, v[32:33], s[20:21] sc0 sc1
    s_mov_b64 exec, s[56:57]
    s_barrier
    s_add_u32 s54, s54, 4
    v_mov_b32 v34, 0
    v_lshlrev_b32 v35, 16, v12
    v_lshlrev_b32 v37, 16, v16
    v_and_b32 v36, 0xffff0000, v12
    v_and_b32 v33, 0xffff0000, v16
    v_mul_f32 v32, v35, v37
    v_mul_f32 v33, v36, v33
    v_cvt_pk_bf16_f32 v32, v32, v33
    v_lshlrev_b32 v33, 16, v32
    v_and_b32 v32, 0xffff0000, v32
    v_add_f32 v34, v34, v33
    v_add_f32 v34, v34, v32
    v_lshlrev_b32 v35, 16, v13
    v_lshlrev_b32 v37, 16, v17
    v_and_b32 v36, 0xffff0000, v13
    v_and_b32 v33, 0xffff0000, v17
    v_mul_f32 v32, v35, v37
    v_mul_f32 v33, v36, v33
    v_cvt_pk_bf16_f32 v32, v32, v33
    v_lshlrev_b32 v33, 16, v32
    v_and_b32 v32, 0xffff0000, v32
    v_add_f32 v34, v34, v33
    v_add_f32 v34, v34, v32
    v_lshlrev_b32 v35, 16, v14
    v_lshlrev_b32 v37, 16, v18
    v_and_b32 v36, 0xffff0000, v14
    v_and_b32 v33, 0xffff0000, v18
    v_mul_f32 v32, v35, v37
    v_mul_f32 v33, v36, v33
    v_cvt_pk_bf16_f32 v32, v32, v33
    v_lshlrev_b32 v33, 16, v32
    v_and_b32 v32, 0xffff0000, v32
    v_add_f32 v34, v34, v33
    v_add_f32 v34, v34, v32
    v_lshlrev_b32 v35, 16, v15
    v_lshlrev_b32 v37, 16, v19
    v_and_b32 v36, 0xffff0000, v15
    v_and_b32 v33, 0xffff0000, v19
    v_mul_f32 v32, v35, v37
    v_mul_f32 v33, v36, v33
    v_cvt_pk_bf16_f32 v32, v32, v33
    v_lshlrev_b32 v33, 16, v32
    v_and_b32 v32, 0xffff0000, v32
    v_add_f32 v34, v34, v33
    v_add_f32 v34, v34, v32
    s_nop 1
    v_add_f32_dpp v34, v34, v34 row_ror:8 row_mask:0xf bank_mask:0xf
    s_nop 1
    v_add_f32_dpp v34, v34, v34 row_ror:4 row_mask:0xf bank_mask:0xf
    s_nop 1
    v_add_f32_dpp v34, v34, v34 row_ror:2 row_mask:0xf bank_mask:0xf
    s_nop 1
    v_add_f32_dpp v34, v34, v34 row_ror:1 row_mask:0xf bank_mask:0xf
    s_nop 1
    v_readlane_b32 s49, v34, 0
    v_readlane_b32 s50, v34, 16
    v_readlane_b32 s56, v34, 32
    v_readlane_b32 s57, v34, 48
    s_nop 1
    v_mov_b32 v34, s49
    v_add_f32 v34, s50, v34
    v_add_f32 v34, s56, v34
    v_add_f32 v34, s57, v34
    v_cvt_pk_bf16_f32 v34, v34, v34
    v_and_b32 v34, 0xffff0000, v34
    v_mul_f32 v34, 0xbfb8aa3b, v34
    v_exp_f32 v34, v34
    s_nop 0
    v_add_f32 v34, 1.0, v34
    v_rcp_f32 v34, v34
    s_nop 0
    v_cvt_pk_bf16_f32 v34, v34, v34
    v_and_b32 v32, 0xffff0000, v34
    v_sub_f32 v33, 1.0, v32
    v_cvt_pk_bf16_f32 v33, v33, v33
    v_and_b32 v33, 0xffff0000, v33
    s_lshl_b32 s49, s54, 3
    s_add_u32 s49, s49, 11091968
    v_mov_b32 v35, s49
    v_cmp_eq_u32 vcc, 0, v1
    s_and_saveexec_b64 s[56:57], vcc
    global_store_dwordx2 v35, v[32:33], s[20:21] sc0 sc1
    s_mov_b64 exec, s[56:57]
    s_barrier
    v_bfe_u32 v3, v1, 2, 2
    v_lshrrev_b32 v4, 5, v1
    v_lshl_add_u32 v4, v4, 3, v3
    v_lshlrev_b32 v4, 6, v4
    v_and_b32 v5, 3, v1
    v_bfe_u32 v6, v1, 4, 1
    v_lshl_add_u32 v5, v6, 2, v5
    v_and_b32 v6, 1, v5
    v_lshlrev_b32 v6, 2, v6
    v_lshrrev_b32 v5, 1, v5
    v_add_u32 v5, v5, v6
    v_lshl_add_u32 v4, v5, 3, v4
    v_add_u32 v4, s55, v4
    ds_read_b64_tr_b16 v[8:9], v4
    ds_read_b64_tr_b16 v[10:11], v4 offset:256
    v_lshlrev_b32 v5, 4, v1
    v_add_u32 v5, s53, v5
    s_waitcnt lgkmcnt(0)
    global_store_dwordx4 v5, v[8:11], s[20:21] sc0 sc1
    s_barrier
    s_barrier
    s_barrier
    s_barrier
    s_barrier
    s_endpgm
L_k1_ssmld:
    global_load_ushort v20, v5, s[8:9]
    global_load_ushort v21, v5, s[10:11]
    global_load_ushort v22, v5, s[16:17]
    s_branch L_k1_ssm
L_k1_qkv0:
    s_waitcnt lgkmcnt(0)
L_k1_qkv:
    v_and_b32 v3, 31, v1
    v_lshrrev_b32 v4, 5, v1
    v_bfe_u32 v5, v3, 1, 3
    v_lshlrev_b32 v3, 7, v3
    v_or_b32 v6, 0, v4
    v_xor_b32 v6, v6, v5
    v_lshl_add_u32 v24, v6, 4, v3
    v_or_b32 v6, 2, v4
    v_xor_b32 v6, v6, v5
    v_lshl_add_u32 v25, v6, 4, v3
    v_or_b32 v6, 4, v4
    v_xor_b32 v6, v6, v5
    v_lshl_add_u32 v26, v6, 4, v3
    v_or_b32 v6, 6, v4
    v_xor_b32 v6, v6, v5
    v_lshl_add_u32 v27, v6, 4, v3
    s_and_b32 s50, s22, 1
    s_lshl_b32 s49, s50, 13
    v_add_u32 v24, s49, v24
    v_add_u32 v25, s49, v25
    v_add_u32 v26, s49, v26
    v_add_u32 v27, s49, v27
    v_bfe_u32 v3, v1, 2, 2
    v_lshrrev_b32 v4, 5, v1
    v_lshl_add_u32 v4, v4, 3, v3
    v_mul_u32_u24 v4, 128, v4
    v_lshrrev_b32 v3, 1, v3
    s_lshr_b32 s56, s22, 1
    v_xor_b32 v3, s56, v3
    v_lshl_add_u32 v3, v3, 6, v4
    v_and_b32 v4, 3, v1
    v_bfe_u32 v5, v1, 4, 1
    v_lshl_add_u32 v4, v5, 2, v4
    v_lshl_add_u32 v29, v4, 3, v3
    v_and_b32 v5, 4, v4
    v_bfe_u32 v6, v4, 1, 1
    v_or_b32 v5, v5, v6
    v_and_b32 v6, 1, v4
    v_lshl_or_b32 v5, v6, 1, v5
    v_lshl_add_u32 v28, v5, 3, v3
    v_mov_b32 v32, 0
    v_mov_b32 v33, 0
    v_mov_b32 v34, 0
    v_mov_b32 v35, 0
    v_mov_b32 v36, 0
    v_mov_b32 v37, 0
    v_mov_b32 v38, 0
    v_mov_b32 v39, 0
    v_mov_b32 v40, 0
    v_mov_b32 v41, 0
    v_mov_b32 v42, 0
    v_mov_b32 v43, 0
    v_mov_b32 v44, 0
    v_mov_b32 v45, 0
    v_mov_b32 v46, 0
    v_mov_b32 v47, 0
    v_mov_b32 v48, 0
    v_mov_b32 v49, 0
    v_mov_b32 v50, 0
    v_mov_b32 v51, 0
    v_mov_b32 v52, 0
    v_mov_b32 v53, 0
    v_mov_b32 v54, 0
    v_mov_b32 v55, 0
    v_mov_b32 v56, 0
    v_mov_b32 v57, 0
    v_mov_b32 v58, 0
    v_mov_b32 v59, 0
    v_mov_b32 v60, 0
    v_mov_b32 v61, 0
    v_mov_b32 v62, 0
    v_mov_b32 v63, 0
    v_mov_b32 v64, 0
    v_mov_b32 v65, 0
    v_mov_b32 v66, 0
    v_mov_b32 v67, 0
    v_mov_b32 v68, 0
    v_mov_b32 v69, 0
    v_mov_b32 v70, 0
    v_mov_b32 v71, 0
    v_mov_b32 v72, 0
    v_mov_b32 v73, 0
    v_mov_b32 v74, 0
    v_mov_b32 v75, 0
    v_mov_b32 v76, 0
    v_mov_b32 v77, 0
    v_mov_b32 v78, 0
    v_mov_b32 v79, 0
    v_mov_b32 v80, 0
    v_mov_b32 v81, 0
    v_mov_b32 v82, 0
    v_mov_b32 v83, 0
    v_mov_b32 v84, 0
    v_mov_b32 v85, 0
    v_mov_b32 v86, 0
    v_mov_b32 v87, 0
    v_mov_b32 v88, 0
    v_mov_b32 v89, 0
    v_mov_b32 v90, 0
    v_mov_b32 v91, 0
    v_mov_b32 v92, 0
    v_mov_b32 v93, 0
    v_mov_b32 v94, 0
    v_mov_b32 v95, 0
    v_mov_b32 v96, 0
    v_mov_b32 v97, 0
    v_mov_b32 v98, 0
    v_mov_b32 v99, 0
    v_mov_b32 v100, 0
    v_mov_b32 v101, 0
    v_mov_b32 v102, 0
    v_mov_b32 v103, 0
    v_mov_b32 v104, 0
    v_mov_b32 v105, 0
    v_mov_b32 v106, 0
    v_mov_b32 v107, 0
    v_mov_b32 v108, 0
    v_mov_b32 v109, 0
    v_mov_b32 v110, 0
    v_mov_b32 v111, 0
    v_mov_b32 v112, 0
    v_mov_b32 v113, 0
    v_mov_b32 v114, 0
    v_mov_b32 v115, 0
    v_mov_b32 v116, 0
    v_mov_b32 v117, 0
    v_mov_b32 v118, 0
    v_mov_b32 v119, 0
    v_mov_b32 v120, 0
    v_mov_b32 v121, 0
    v_mov_b32 v122, 0
    v_mov_b32 v123, 0
    v_mov_b32 v124, 0
    v_mov_b32 v125, 0
    v_mov_b32 v126, 0
    v_mov_b32 v127, 0
    s_setprio 0
    s_mov_b32 s44, 0
    s_mov_b32 s48, 0
    s_mov_b32 s59, 0xfffec000
    s_barrier
    ds_read_b128 v[8:11], v24 offset:0
    ds_read_b128 v[12:15], v24 offset:4096
    ds_read_b64_tr_b16 v[132:133], v28 offset:16384
    ds_read_b64_tr_b16 v[134:135], v28 offset:16896
    ds_read_b64_tr_b16 v[136:137], v28 offset:24576
    ds_read_b64_tr_b16 v[138:139], v28 offset:25088
    ds_read_b64_tr_b16 v[140:141], v29 offset:32768
    ds_read_b64_tr_b16 v[142:143], v29 offset:33280
L_k1_r0_loop:
    s_waitcnt lgkmcnt(0)
    v_mfma_f32_32x32x16_bf16 v[32:47], v[132:135], v[8:11], v[32:47]
    ds_read_b128 v[16:19], v25 offset:0
    ds_read_b128 v[128:131], v25 offset:4096
    ds_read_b64_tr_b16 v[144:145], v28 offset:18432
    v_mfma_f32_32x32x16_bf16 v[80:95], v[132:135], v[12:15], v[80:95]
    ds_read_b64_tr_b16 v[146:147], v28 offset:18944
    ds_read_b64_tr_b16 v[148:149], v28 offset:26624
    ds_read_b64_tr_b16 v[150:151], v28 offset:27136
    v_mfma_f32_32x32x16_bf16 v[48:63], v[136:139], v[8:11], v[48:63]
    ds_read_b64_tr_b16 v[152:153], v29 offset:34816
    ds_read_b64_tr_b16 v[154:155], v29 offset:35328
    v_mfma_f32_32x32x16_bf16 v[96:111], v[136:139], v[12:15], v[96:111]
    v_mfma_f32_32x32x16_bf16 v[64:79], v[8:11], v[140:143], v[64:79]
    v_mfma_f32_32x32x16_bf16 v[112:127], v[12:15], v[140:143], v[112:127]
    s_waitcnt lgkmcnt(0)
    v_mfma_f32_32x32x16_bf16 v[32:47], v[144:147], v[16:19], v[32:47]
    ds_read_b128 v[8:11], v26 offset:0
    ds_read_b128 v[12:15], v26 offset:4096
    ds_read_b64_tr_b16 v[132:133], v28 offset:20480
    v_mfma_f32_32x32x16_bf16 v[80:95], v[144:147], v[128:131], v[80:95]
    ds_read_b64_tr_b16 v[134:135], v28 offset:20992
    ds_read_b64_tr_b16 v[136:137], v28 offset:28672
    ds_read_b64_tr_b16 v[138:139], v28 offset:29184
    v_mfma_f32_32x32x16_bf16 v[48:63], v[148:151], v[16:19], v[48:63]
    ds_read_b64_tr_b16 v[140:141], v29 offset:36864
    ds_read_b64_tr_b16 v[142:143], v29 offset:37376
    v_mfma_f32_32x32x16_bf16 v[96:111], v[148:151], v[128:131], v[96:111]
    v_mfma_f32_32x32x16_bf16 v[64:79], v[16:19], v[152:155], v[64:79]
    v_mfma_f32_32x32x16_bf16 v[112:127], v[128:131], v[152:155], v[112:127]
    s_waitcnt lgkmcnt(0)
    v_mfma_f32_32x32x16_bf16 v[32:47], v[132:135], v[8:11], v[32:47]
    ds_read_b128 v[16:19], v27 offset:0
    ds_read_b128 v[128:131], v27 offset:4096
    ds_read_b64_tr_b16 v[144:145], v28 offset:22528
    v_mfma_f32_32x32x16_bf16 v[80:95], v[132:135], v[12:15], v[80:95]
    ds_read_b64_tr_b16 v[146:147], v28 offset:23040
    ds_read_b64_tr_b16 v[148:149], v28 offset:30720
    ds_read_b64_tr_b16 v[150:151], v28 offset:31232
    v_mfma_f32_32x32x16_bf16 v[48:63], v[136:139], v[8:11], v[48:63]
    ds_read_b64_tr_b16 v[152:153], v29 offset:38912
    ds_read_b64_tr_b16 v[154:155], v29 offset:39424
    v_mfma_f32_32x32x16_bf16 v[96:111], v[136:139], v[12:15], v[96:111]
    v_mfma_f32_32x32x16_bf16 v[64:79], v[8:11], v[140:143], v[64:79]
    v_mfma_f32_32x32x16_bf16 v[112:127], v[12:15], v[140:143], v[112:127]
    s_add_u32 s48, s48, 1
    s_cmp_eq_u32 s48, 3
    s_cselect_b32 s53, s59, 40960
    s_cselect_b32 s48, 0, s48
    v_add_u32 v24, s53, v24
    v_add_u32 v25, s53, v25
    v_add_u32 v26, s53, v26
    v_add_u32 v27, s53, v27
    v_add_u32 v28, s53, v28
    v_add_u32 v29, s53, v29
    s_add_u32 s44, s44, 1
    s_waitcnt lgkmcnt(0)
    s_cmp_lt_u32 s44, 8
    s_cbranch_scc0 L_k1_r0_last
    s_barrier
    v_mfma_f32_32x32x16_bf16 v[32:47], v[144:147], v[16:19], v[32:47]
    ds_read_b128 v[8:11], v24 offset:0
    ds_read_b128 v[12:15], v24 offset:4096
    ds_read_b64_tr_b16 v[132:133], v28 offset:16384
    v_mfma_f32_32x32x16_bf16 v[80:95], v[144:147], v[128:131], v[80:95]
    ds_read_b64_tr_b16 v[134:135], v28 offset:16896
    ds_read_b64_tr_b16 v[136:137], v28 offset:24576
    ds_read_b64_tr_b16 v[138:139], v28 offset:25088
    v_mfma_f32_32x32x16_bf16 v[48:63], v[148:151], v[16:19], v[48:63]
    ds_read_b64_tr_b16 v[140:141], v29 offset:32768
    ds_read_b64_tr_b16 v[142:143], v29 offset:33280
    v_mfma_f32_32x32x16_bf16 v[96:111], v[148:151], v[128:131], v[96:111]
    v_mfma_f32_32x32x16_bf16 v[64:79], v[16:19], v[152:155], v[64:79]
    v_mfma_f32_32x32x16_bf16 v[112:127], v[128:131], v[152:155], v[112:127]
    s_branch L_k1_r0_loop
L_k1_r0_last:
    v_mfma_f32_32x32x16_bf16 v[32:47], v[144:147], v[16:19], v[32:47]
    v_mfma_f32_32x32x16_bf16 v[80:95], v[144:147], v[128:131], v[80:95]
    v_mfma_f32_32x32x16_bf16 v[48:63], v[148:151], v[16:19], v[48:63]
    v_mfma_f32_32x32x16_bf16 v[96:111], v[148:151], v[128:131], v[96:111]
    v_mfma_f32_32x32x16_bf16 v[64:79], v[16:19], v[152:155], v[64:79]
    v_mfma_f32_32x32x16_bf16 v[112:127], v[128:131], v[152:155], v[112:127]
    s_nop 7
    s_nop 7
    s_and_b32 s50, s22, 1
    s_lshl_b32 s50, s50, 1
    s_lshl_b32 s49, s26, 2
    s_add_u32 s49, s49, s50
    s_lshl_b32 s49, s49, 10
    s_lshl_b32 s50, s25, 17
    s_add_u32 s49, s49, s50
    v_and_b32 v3, 31, v1
    v_lshrrev_b32 v4, 5, v1
    v_lshlrev_b32 v4, 9, v4
    v_bfe_u32 v5, v3, 2, 1
    v_lshlrev_b32 v5, 4, v5
    v_bfe_u32 v6, v3, 3, 2
    v_lshl_add_u32 v5, v6, 2, v5
    v_and_b32 v6, 3, v3
    v_add_u32 v5, v5, v6
    v_lshl_add_u32 v20, v5, 4, v4
    v_add_u32 v20, s49, v20
    v_and_b32 v5, 0x13, v3
    v_bfe_u32 v6, v3, 2, 1
    v_lshl_or_b32 v5, v6, 3, v5
    v_bfe_u32 v6, v3, 3, 1
    v_lshl_or_b32 v5, v6, 2, v5
    v_lshl_add_u32 v21, v5, 4, v4
    v_add_u32 v21, s49, v21
    v_add_u32 v21, 2097152, v21
    v_bfe_u32 v5, v3, 2, 1
    v_lshlrev_b32 v5, 3, v5
    v_bfe_u32 v6, v3, 3, 1
    v_lshl_or_b32 v5, v6, 2, v5
    v_and_b32 v6, 3, v3
    v_or_b32 v5, v5, v6
    v_lshlrev_b32 v5, 4, v5
    v_lshrrev_b32 v6, 1, v4
    v_add_u32 v5, v5, v6
    v_lshrrev_b32 v6, 4, v3
    v_lshl_add_u32 v5, v6, 16, v5
    v_add_u32 v22, s49, v5
    v_add_u32 v22, 4194304, v22
    s_mov_b32 s49, 0x3eb8aa3b
    v_cvt_pk_bf16_f32 v140, v48, v49
    v_cvt_pk_bf16_f32 v141, v50, v51
    v_cvt_pk_bf16_f32 v142, v52, v53
    v_cvt_pk_bf16_f32 v143, v54, v55
    v_cvt_pk_bf16_f32 v144, v56, v57
    v_cvt_pk_bf16_f32 v145, v58, v59
    v_cvt_pk_bf16_f32 v146, v60, v61
    v_cvt_pk_bf16_f32 v147, v62, v63
    v_add_u32 v3, 0, v21
    v_add_u32 v4, 65536, v21
    global_store_dwordx4 v3, v[140:143], s[20:21] sc0 sc1
    global_store_dwordx4 v4, v[144:147], s[20:21] sc0 sc1
    s_nop 1
    v_cvt_pk_bf16_f32 v132, v64, v65
    v_cvt_pk_bf16_f32 v133, v66, v67
    v_cvt_pk_bf16_f32 v134, v68, v69
    v_cvt_pk_bf16_f32 v135, v70, v71
    v_cvt_pk_bf16_f32 v136, v72, v73
    v_cvt_pk_bf16_f32 v137, v74, v75
    v_cvt_pk_bf16_f32 v138, v76, v77
    v_cvt_pk_bf16_f32 v139, v78, v79
    global_store_dwordx4 v22, v[132:135], s[20:21] offset:0 sc0 sc1
    global_store_dwordx4 v22, v[136:139], s[20:21] offset:512 sc0 sc1
    s_nop 1
    v_mul_f32 v32, s49, v32
    v_mul_f32 v33, s49, v33
    v_mul_f32 v34, s49, v34
    v_mul_f32 v35, s49, v35
    v_mul_f32 v36, s49, v36
    v_mul_f32 v37, s49, v37
    v_mul_f32 v38, s49, v38
    v_mul_f32 v39, s49, v39
    v_mul_f32 v40, s49, v40
    v_mul_f32 v41, s49, v41
    v_mul_f32 v42, s49, v42
    v_mul_f32 v43, s49, v43
    v_mul_f32 v44, s49, v44
    v_mul_f32 v45, s49, v45
    v_mul_f32 v46, s49, v46
    v_mul_f32 v47, s49, v47
    v_cvt_pk_bf16_f32 v132, v32, v33
    v_cvt_pk_bf16_f32 v133, v34, v35
    v_cvt_pk_bf16_f32 v134, v36, v37
    v_cvt_pk_bf16_f32 v135, v38, v39
    v_cvt_pk_bf16_f32 v136, v40, v41
    v_cvt_pk_bf16_f32 v137, v42, v43
    v_cvt_pk_bf16_f32 v138, v44, v45
    v_cvt_pk_bf16_f32 v139, v46, v47
    v_add_u32 v3, 0, v20
    v_add_u32 v4, 65536, v20
    global_store_dwordx4 v3, v[132:135], s[20:21] sc0 sc1
    global_store_dwordx4 v4, v[136:139], s[20:21] sc0 sc1
    s_nop 1
    v_cvt_pk_bf16_f32 v132, v96, v97
    v_cvt_pk_bf16_f32 v133, v98, v99
    v_cvt_pk_bf16_f32 v134, v100, v101
    v_cvt_pk_bf16_f32 v135, v102, v103
    v_cvt_pk_bf16_f32 v136, v104, v105
    v_cvt_pk_bf16_f32 v137, v106, v107
    v_cvt_pk_bf16_f32 v138, v108, v109
    v_cvt_pk_bf16_f32 v139, v110, v111
    v_add_u32 v3, 1024, v21
    v_add_u32 v4, 66560, v21
    global_store_dwordx4 v3, v[132:135], s[20:21] sc0 sc1
    global_store_dwordx4 v4, v[136:139], s[20:21] sc0 sc1
    s_nop 1
    v_cvt_pk_bf16_f32 v140, v112, v113
    v_cvt_pk_bf16_f32 v141, v114, v115
    v_cvt_pk_bf16_f32 v142, v116, v117
    v_cvt_pk_bf16_f32 v143, v118, v119
    v_cvt_pk_bf16_f32 v144, v120, v121
    v_cvt_pk_bf16_f32 v145, v122, v123
    v_cvt_pk_bf16_f32 v146, v124, v125
    v_cvt_pk_bf16_f32 v147, v126, v127
    global_store_dwordx4 v22, v[140:143], s[20:21] offset:1024 sc0 sc1
    global_store_dwordx4 v22, v[144:147], s[20:21] offset:1536 sc0 sc1
    s_nop 1
    v_mul_f32 v80, s49, v80
    v_mul_f32 v81, s49, v81
    v_mul_f32 v82, s49, v82
    v_mul_f32 v83, s49, v83
    v_mul_f32 v84, s49, v84
    v_mul_f32 v85, s49, v85
    v_mul_f32 v86, s49, v86
    v_mul_f32 v87, s49, v87
    v_mul_f32 v88, s49, v88
    v_mul_f32 v89, s49, v89
    v_mul_f32 v90, s49, v90
    v_mul_f32 v91, s49, v91
    v_mul_f32 v92, s49, v92
    v_mul_f32 v93, s49, v93
    v_mul_f32 v94, s49, v94
    v_mul_f32 v95, s49, v95
    v_cvt_pk_bf16_f32 v140, v80, v81
    v_cvt_pk_bf16_f32 v141, v82, v83
    v_cvt_pk_bf16_f32 v142, v84, v85
    v_cvt_pk_bf16_f32 v143, v86, v87
    v_cvt_pk_bf16_f32 v144, v88, v89
    v_cvt_pk_bf16_f32 v145, v90, v91
    v_cvt_pk_bf16_f32 v146, v92, v93
    v_cvt_pk_bf16_f32 v147, v94, v95
    v_add_u32 v3, 1024, v20
    v_add_u32 v4, 66560, v20
    global_store_dwordx4 v3, v[140:143], s[20:21] sc0 sc1
    global_store_dwordx4 v4, v[144:147], s[20:21] sc0 sc1
    s_nop 1
    s_endpgm
L_k1_ssm:
    v_and_b32 v3, 31, v1
    v_lshrrev_b32 v4, 5, v1
    v_bfe_u32 v5, v3, 1, 3
    v_lshlrev_b32 v3, 7, v3
    v_or_b32 v6, 0, v4
    v_xor_b32 v6, v6, v5
    v_lshl_add_u32 v24, v6, 4, v3
    v_or_b32 v6, 2, v4
    v_xor_b32 v6, v6, v5
    v_lshl_add_u32 v25, v6, 4, v3
    v_or_b32 v6, 4, v4
    v_xor_b32 v6, v6, v5
    v_lshl_add_u32 v26, v6, 4, v3
    v_or_b32 v6, 6, v4
    v_xor_b32 v6, v6, v5
    v_lshl_add_u32 v27, v6, 4, v3
    s_and_b32 s50, s22, 3
    s_lshl_b32 s49, s50, 12
    s_lshr_b32 s56, s22, 2
    s_lshl_b32 s56, s56, 13
    v_add_u32 v28, s56, v24
    v_add_u32 v29, s56, v25
    v_add_u32 v30, s56, v26
    v_add_u32 v31, s56, v27
    v_add_u32 v24, s49, v24
    v_add_u32 v25, s49, v25
    v_add_u32 v26, s49, v26
    v_add_u32 v27, s49, v27
    v_mov_b32 v32, 0
    v_mov_b32 v33, 0
    v_mov_b32 v34, 0
    v_mov_b32 v35, 0
    v_mov_b32 v36, 0
    v_mov_b32 v37, 0
    v_mov_b32 v38, 0
    v_mov_b32 v39, 0
    v_mov_b32 v40, 0
    v_mov_b32 v41, 0
    v_mov_b32 v42, 0
    v_mov_b32 v43, 0
    v_mov_b32 v44, 0
    v_mov_b32 v45, 0
    v_mov_b32 v46, 0
    v_mov_b32 v47, 0
    v_mov_b32 v48, 0
    v_mov_b32 v49, 0
    v_mov_b32 v50, 0
    v_mov_b32 v51, 0
    v_mov_b32 v52, 0
    v_mov_b32 v53, 0
    v_mov_b32 v54, 0
    v_mov_b32 v55, 0
    v_mov_b32 v56, 0
    v_mov_b32 v57, 0
    v_mov_b32 v58, 0
    v_mov_b32 v59, 0
    v_mov_b32 v60, 0
    v_mov_b32 v61, 0
    v_mov_b32 v62, 0
    v_mov_b32 v63, 0
    s_waitcnt vmcnt(0)
    v_mov_b32 v66, 0
    v_lshlrev_b32 v67, 16, v8
    v_lshlrev_b32 v69, 16, v16
    v_and_b32 v68, 0xffff0000, v8
    v_and_b32 v65, 0xffff0000, v16
    v_mul_f32 v64, v67, v69
    v_mul_f32 v65, v68, v65
    v_cvt_pk_bf16_f32 v64, v64, v65
    v_lshlrev_b32 v65, 16, v64
    v_and_b32 v64, 0xffff0000, v64
    v_add_f32 v66, v66, v65
    v_add_f32 v66, v66, v64
    v_lshlrev_b32 v67, 16, v9
    v_lshlrev_b32 v69, 16, v17
    v_and_b32 v68, 0xffff0000, v9
    v_and_b32 v65, 0xffff0000, v17
    v_mul_f32 v64, v67, v69
    v_mul_f32 v65, v68, v65
    v_cvt_pk_bf16_f32 v64, v64, v65
    v_lshlrev_b32 v65, 16, v64
    v_and_b32 v64, 0xffff0000, v64
    v_add_f32 v66, v66, v65
    v_add_f32 v66, v66, v64
    v_lshlrev_b32 v67, 16, v10
    v_lshlrev_b32 v69, 16, v18
    v_and_b32 v68, 0xffff0000, v10
    v_and_b32 v65, 0xffff0000, v18
    v_mul_f32 v64, v67, v69
    v_mul_f32 v65, v68, v65
    v_cvt_pk_bf16_f32 v64, v64, v65
    v_lshlrev_b32 v65, 16, v64
    v_and_b32 v64, 0xffff0000, v64
    v_add_f32 v66, v66, v65
    v_add_f32 v66, v66, v64
    v_lshlrev_b32 v67, 16, v11
    v_lshlrev_b32 v69, 16, v19
    v_and_b32 v68, 0xffff0000, v11
    v_and_b32 v65, 0xffff0000, v19
    v_mul_f32 v64, v67, v69
    v_mul_f32 v65, v68, v65
    v_cvt_pk_bf16_f32 v64, v64, v65
    v_lshlrev_b32 v65, 16, v64
    v_and_b32 v64, 0xffff0000, v64
    v_add_f32 v66, v66, v65
    v_add_f32 v66, v66, v64
    s_nop 1
    v_add_f32_dpp v66, v66, v66 row_ror:8 row_mask:0xf bank_mask:0xf
    s_nop 1
    v_add_f32_dpp v66, v66, v66 row_ror:4 row_mask:0xf bank_mask:0xf
    s_nop 1
    v_add_f32_dpp v66, v66, v66 row_ror:2 row_mask:0xf bank_mask:0xf
    s_nop 1
    v_add_f32_dpp v66, v66, v66 row_ror:1 row_mask:0xf bank_mask:0xf
    s_nop 1
    v_readlane_b32 s49, v66, 0
    v_readlane_b32 s50, v66, 16
    v_readlane_b32 s56, v66, 32
    v_readlane_b32 s57, v66, 48
    s_nop 1
    v_mov_b32 v66, s49
    v_add_f32 v66, s50, v66
    v_add_f32 v66, s56, v66
    v_add_f32 v66, s57, v66
    v_cvt_pk_bf16_f32 v66, v66, v66
    v_and_b32 v66, 0xffff0000, v66
    v_mul_f32 v66, 0xbfb8aa3b, v66
    v_exp_f32 v66, v66
    s_nop 0
    v_add_f32 v66, 1.0, v66
    v_rcp_f32 v66, v66
    s_nop 0
    v_cvt_pk_bf16_f32 v66, v66, v66
    v_and_b32 v64, 0xffff0000, v66
    v_sub_f32 v65, 1.0, v64
    v_cvt_pk_bf16_f32 v65, v65, v65
    v_and_b32 v65, 0xffff0000, v65
    s_lshl_b32 s49, s54, 3
    s_add_u32 s49, s49, 11091968
    v_mov_b32 v67, s49
    v_cmp_eq_u32 vcc, 0, v1
    s_and_saveexec_b64 s[56:57], vcc
    global_store_dwordx2 v67, v[64:65], s[20:21] sc0 sc1
    s_mov_b64 exec, s[56:57]
    v_lshlrev_b32 v20, 16, v20
    v_lshlrev_b32 v21, 16, v21
    v_lshlrev_b32 v22, 16, v22
    v_mul_f32 v72, 0x3fb8aa3b, v22
    v_exp_f32 v72, v72
    s_nop 0
    v_cvt_pk_bf16_f32 v72, v72, v72
    v_and_b32 v72, 0xffff0000, v72
    v_mul_f32 v73, v72, v20
    v_mul_f32 v74, v72, v21
    v_mul_f32 v73, 0x3fb8aa3b, v73
    v_exp_f32 v73, v73
    v_mul_f32 v74, 0.15915494, v74
    v_rndne_f32 v75, v74
    v_sub_f32 v74, v74, v75
    v_cos_f32 v75, v74
    v_sin_f32 v76, v74
    s_nop 0
    v_mul_f32 v64, v73, v75
    v_mul_f32 v65, v73, v76
    v_add_f32 v72, -1.0, v64
    v_mul_f32 v73, v20, v20
    v_fma_f32 v73, v21, v21, v73
    v_rcp_f32 v73, v73
    v_mul_f32 v74, v72, v20
    v_fma_f32 v74, v65, v21, v74
    v_mul_f32 v75, v65, v20
    v_fma_f32 v75, -v72, v21, v75
    v_mul_f32 v66, v74, v73
    v_mul_f32 v67, v75, v73
    v_mul_f32 v76, v65, v65
    v_fma_f32 v72, v64, v64, -v76
    v_add_f32 v76, v64, v64
    v_mul_f32 v73, v76, v65
    v_mul_f32 v76, v73, v73
    v_fma_f32 v74, v72, v72, -v76
    v_add_f32 v76, v72, v72
    v_mul_f32 v75, v76, v73
    v_mul_f32 v76, v75, v75
    v_fma_f32 v72, v74, v74, -v76
    v_add_f32 v76, v74, v74
    v_mul_f32 v73, v76, v75
    v_mul_f32 v76, v73, v73
    v_fma_f32 v68, v72, v72, -v76
    v_add_f32 v76, v72, v72
    v_mul_f32 v69, v76, v73
    v_mul_f32 v76, v69, v69
    v_fma_f32 v72, v68, v68, -v76
    v_add_f32 v76, v68, v68
    v_mul_f32 v73, v76, v69
    v_mul_f32 v76, v73, v73
    v_fma_f32 v74, v72, v72, -v76
    v_add_f32 v76, v72, v72
    v_mul_f32 v75, v76, v73
    v_mul_f32 v76, v75, v75
    v_fma_f32 v70, v74, v74, -v76
    v_add_f32 v76, v74, v74
    v_mul_f32 v71, v76, v75
    s_and_b32 s49, s22, 3
    s_or_b32 s49, s49, s26
    s_cmp_eq_u32 s49, 0
    s_cbranch_scc0 L_k1_nopar
    v_and_b32 v72, 31, v1
    s_lshl_b32 s49, s25, 5
    v_add_u32 v72, s49, v72
    v_lshlrev_b32 v72, 5, v72
    v_add_u32 v72, 11075584, v72
    v_cmp_gt_u32 vcc, 32, v1
    s_and_saveexec_b64 s[56:57], vcc
    global_store_dwordx2 v72, v[64:65], s[20:21] sc0 sc1
    global_store_dwordx2 v72, v[68:69], s[20:21] offset:8 sc0 sc1
    global_store_dwordx2 v72, v[70:71], s[20:21] offset:16 sc0 sc1
    s_mov_b64 exec, s[56:57]
L_k1_nopar:
    v_mov_b32 v72, -1
    v_mov_b32 v73, -1
    v_mov_b32 v74, -1
    v_mov_b32 v75, -1
    s_lshl_b32 s56, s26, 3
    s_add_u32 s56, s56, s3
    s_lshl_b32 s56, s56, 3
    s_add_u32 s56, s56, s22
    s_lshl_b32 s56, s56, 1
    s_lshr_b32 s57, s56, 5
    s_mul_i32 s57, s57, 96
    s_and_b32 s56, s56, 31
    s_add_u32 s56, s56, s57
    s_lshl_b32 s56, s56, 10
    s_add_u32 s56, s56, 11534336
    v_lshlrev_b32 v6, 4, v1
    v_add_u32 v6, s56, v6
    global_store_dwordx4 v6, v[72:75], s[20:21] sc0 sc1
    global_store_dwordx4 v6, v[72:75], s[20:21] offset:1024 sc0 sc1
    s_setprio 0
    s_mov_b32 s44, 0
    s_mov_b32 s48, 0
    s_mov_b32 s59, 0xfffec000
    s_barrier
    s_lshl_b32 s56, s26, 3
    s_add_u32 s56, s56, s3
    s_lshl_b32 s57, s56, 3
    s_add_u32 s57, s57, s22
    s_bitcmp1_b32 s57, 5
    s_cselect_b32 s28, s62, s60
    s_cselect_b32 s29, s63, s61
    v_and_b32 v3, 31, v1
    v_bfe_u32 v4, v3, 2, 1
    v_lshlrev_b32 v4, 4, v4
    v_bfe_u32 v5, v3, 3, 2
    v_lshl_add_u32 v4, v5, 2, v4
    v_and_b32 v5, 3, v3
    v_add_u32 v4, v4, v5
    v_lshrrev_b32 v3, 5, v1
    v_lshlrev_b32 v3, 4, v3
    v_lshl_add_u32 v3, v4, 10, v3
    s_lshr_b32 s49, s57, 6
    s_lshl_b32 s49, s49, 15
    s_and_b32 s50, s57, 31
    s_lshl_b32 s50, s50, 5
    s_add_u32 s49, s49, s50
    v_add_u32 v3, s49, v3
    global_load_dwordx4 v[100:103], v3, s[28:29]
    s_lshl_b32 s49, s57, 10
    s_add_u32 s49, s49, 17825792
    v_lshlrev_b32 v108, 4, v1
    v_add_u32 v108, s49, v108
    ds_read_b128 v[76:79], v24
    ds_read_b128 v[84:87], v28 offset:16384
    ds_read_b128 v[88:91], v28 offset:20480
L_k1_r1_loop:
    ds_read_b128 v[80:83], v25
    ds_read_b128 v[92:95], v29 offset:16384
    ds_read_b128 v[96:99], v29 offset:20480
    s_waitcnt lgkmcnt(3)
    v_mfma_f32_32x32x16_bf16 v[32:47], v[76:79], v[84:87], v[32:47]
    v_mfma_f32_32x32x16_bf16 v[48:63], v[76:79], v[88:91], v[48:63]
    ds_read_b128 v[76:79], v26
    ds_read_b128 v[84:87], v30 offset:16384
    ds_read_b128 v[88:91], v30 offset:20480
    s_waitcnt lgkmcnt(3)
    v_mfma_f32_32x32x16_bf16 v[32:47], v[80:83], v[92:95], v[32:47]
    v_mfma_f32_32x32x16_bf16 v[48:63], v[80:83], v[96:99], v[48:63]
    ds_read_b128 v[80:83], v27
    ds_read_b128 v[92:95], v31 offset:16384
    ds_read_b128 v[96:99], v31 offset:20480
    s_waitcnt lgkmcnt(3)
    v_mfma_f32_32x32x16_bf16 v[32:47], v[76:79], v[84:87], v[32:47]
    v_mfma_f32_32x32x16_bf16 v[48:63], v[76:79], v[88:91], v[48:63]
    s_add_u32 s48, s48, 1
    s_cmp_eq_u32 s48, 3
    s_cselect_b32 s53, s59, 40960
    s_cselect_b32 s48, 0, s48
    v_add_u32 v24, s53, v24
    v_add_u32 v25, s53, v25
    v_add_u32 v26, s53, v26
    v_add_u32 v27, s53, v27
    v_add_u32 v28, s53, v28
    v_add_u32 v29, s53, v29
    v_add_u32 v30, s53, v30
    v_add_u32 v31, s53, v31
    s_add_u32 s44, s44, 1
    s_waitcnt lgkmcnt(0)
    s_cmp_eq_u32 s44, 3
    s_cbranch_scc0 L_k1_norp3
    s_waitcnt vmcnt(0)
    global_store_dwordx4 v108, v[100:103], s[20:21] sc0 sc1
L_k1_norp3:
    s_cmp_lt_u32 s44, 8
    s_cbranch_scc0 L_k1_r1_last
    s_barrier
    ds_read_b128 v[76:79], v24
    ds_read_b128 v[84:87], v28 offset:16384
    ds_read_b128 v[88:91], v28 offset:20480
    v_mfma_f32_32x32x16_bf16 v[32:47], v[80:83], v[92:95], v[32:47]
    v_mfma_f32_32x32x16_bf16 v[48:63], v[80:83], v[96:99], v[48:63]
    s_branch L_k1_r1_loop
L_k1_r1_last:
    v_mfma_f32_32x32x16_bf16 v[32:47], v[80:83], v[92:95], v[32:47]
    v_mfma_f32_32x32x16_bf16 v[48:63], v[80:83], v[96:99], v[48:63]
    s_nop 7
    s_nop 7
    v_pk_mul_f32 v[76:77], v[32:33], v[66:67] op_sel_hi:[1,0]
    v_pk_mul_f32 v[92:93], v[48:49], v[66:67] op_sel_hi:[1,0]
    v_pk_fma_f32 v[76:77], v[48:49], v[66:67], v[76:77] op_sel:[0,1,0] op_sel_hi:[1,1,1] neg_lo:[0,1,0] neg_hi:[0,1,0]
    v_pk_fma_f32 v[92:93], v[32:33], v[66:67], v[92:93] op_sel:[0,1,0] op_sel_hi:[1,1,1]
    v_pk_mul_f32 v[78:79], v[34:35], v[66:67] op_sel_hi:[1,0]
    v_pk_mul_f32 v[94:95], v[50:51], v[66:67] op_sel_hi:[1,0]
    v_pk_fma_f32 v[78:79], v[50:51], v[66:67], v[78:79] op_sel:[0,1,0] op_sel_hi:[1,1,1] neg_lo:[0,1,0] neg_hi:[0,1,0]
    v_pk_fma_f32 v[94:95], v[34:35], v[66:67], v[94:95] op_sel:[0,1,0] op_sel_hi:[1,1,1]
    v_pk_mul_f32 v[80:81], v[36:37], v[66:67] op_sel_hi:[1,0]
    v_pk_mul_f32 v[96:97], v[52:53], v[66:67] op_sel_hi:[1,0]
    v_pk_fma_f32 v[80:81], v[52:53], v[66:67], v[80:81] op_sel:[0,1,0] op_sel_hi:[1,1,1] neg_lo:[0,1,0] neg_hi:[0,1,0]
    v_pk_fma_f32 v[96:97], v[36:37], v[66:67], v[96:97] op_sel:[0,1,0] op_sel_hi:[1,1,1]
    v_pk_mul_f32 v[82:83], v[38:39], v[66:67] op_sel_hi:[1,0]
    v_pk_mul_f32 v[98:99], v[54:55], v[66:67] op_sel_hi:[1,0]
    v_pk_fma_f32 v[82:83], v[54:55], v[66:67], v[82:83] op_sel:[0,1,0] op_sel_hi:[1,1,1] neg_lo:[0,1,0] neg_hi:[0,1,0]
    v_pk_fma_f32 v[98:99], v[38:39], v[66:67], v[98:99] op_sel:[0,1,0] op_sel_hi:[1,1,1]
    v_pk_mul_f32 v[84:85], v[40:41], v[66:67] op_sel_hi:[1,0]
    v_pk_mul_f32 v[100:101], v[56:57], v[66:67] op_sel_hi:[1,0]
    v_pk_fma_f32 v[84:85], v[56:57], v[66:67], v[84:85] op_sel:[0,1,0] op_sel_hi:[1,1,1] neg_lo:[0,1,0] neg_hi:[0,1,0]
    v_pk_fma_f32 v[100:101], v[40:41], v[66:67], v[100:101] op_sel:[0,1,0] op_sel_hi:[1,1,1]
    v_pk_mul_f32 v[86:87], v[42:43], v[66:67] op_sel_hi:[1,0]
    v_pk_mul_f32 v[102:103], v[58:59], v[66:67] op_sel_hi:[1,0]
    v_pk_fma_f32 v[86:87], v[58:59], v[66:67], v[86:87] op_sel:[0,1,0] op_sel_hi:[1,1,1] neg_lo:[0,1,0] neg_hi:[0,1,0]
    v_pk_fma_f32 v[102:103], v[42:43], v[66:67], v[102:103] op_sel:[0,1,0] op_sel_hi:[1,1,1]
    v_pk_mul_f32 v[88:89], v[44:45], v[66:67] op_sel_hi:[1,0]
    v_pk_mul_f32 v[104:105], v[60:61], v[66:67] op_sel_hi:[1,0]
    v_pk_fma_f32 v[88:89], v[60:61], v[66:67], v[88:89] op_sel:[0,1,0] op_sel_hi:[1,1,1] neg_lo:[0,1,0] neg_hi:[0,1,0]
    v_pk_fma_f32 v[104:105], v[44:45], v[66:67], v[104:105] op_sel:[0,1,0] op_sel_hi:[1,1,1]
    v_pk_mul_f32 v[90:91], v[46:47], v[66:67] op_sel_hi:[1,0]
    v_pk_mul_f32 v[106:107], v[62:63], v[66:67] op_sel_hi:[1,0]
    v_pk_fma_f32 v[90:91], v[62:63], v[66:67], v[90:91] op_sel:[0,1,0] op_sel_hi:[1,1,1] neg_lo:[0,1,0] neg_hi:[0,1,0]
    v_pk_fma_f32 v[106:107], v[46:47], v[66:67], v[106:107] op_sel:[0,1,0] op_sel_hi:[1,1,1]
    v_fma_f32 v77, v64, v76, v77
    v_fma_f32 v93, v64, v92, v93
    v_fma_f32 v77, -v65, v92, v77
    v_fma_f32 v93, v65, v76, v93
    v_fma_f32 v78, v64, v77, v78
    v_fma_f32 v94, v64, v93, v94
    v_fma_f32 v78, -v65, v93, v78
    v_fma_f32 v94, v65, v77, v94
    v_fma_f32 v79, v64, v78, v79
    v_fma_f32 v95, v64, v94, v95
    v_fma_f32 v79, -v65, v94, v79
    v_fma_f32 v95, v65, v78, v95
    v_fma_f32 v80, v64, v79, v80
    v_fma_f32 v96, v64, v95, v96
    v_fma_f32 v80, -v65, v95, v80
    v_fma_f32 v96, v65, v79, v96
    v_fma_f32 v81, v64, v80, v81
    v_fma_f32 v97, v64, v96, v97
    v_fma_f32 v81, -v65, v96, v81
    v_fma_f32 v97, v65, v80, v97
    v_fma_f32 v82, v64, v81, v82
    v_fma_f32 v98, v64, v97, v98
    v_fma_f32 v82, -v65, v97, v82
    v_fma_f32 v98, v65, v81, v98
    v_fma_f32 v83, v64, v82, v83
    v_fma_f32 v99, v64, v98, v99
    v_fma_f32 v83, -v65, v98, v83
    v_fma_f32 v99, v65, v82, v99
    v_fma_f32 v84, v64, v83, v84
    v_fma_f32 v100, v64, v99, v100
    v_fma_f32 v84, -v65, v99, v84
    v_fma_f32 v100, v65, v83, v100
    v_fma_f32 v85, v64, v84, v85
    v_fma_f32 v101, v64, v100, v101
    v_fma_f32 v85, -v65, v100, v85
    v_fma_f32 v101, v65, v84, v101
    v_fma_f32 v86, v64, v85, v86
    v_fma_f32 v102, v64, v101, v102
    v_fma_f32 v86, -v65, v101, v86
    v_fma_f32 v102, v65, v85, v102
    v_fma_f32 v87, v64, v86, v87
    v_fma_f32 v103, v64, v102, v103
    v_fma_f32 v87, -v65, v102, v87
    v_fma_f32 v103, v65, v86, v103
    v_fma_f32 v88, v64, v87, v88
    v_fma_f32 v104, v64, v103, v104
    v_fma_f32 v88, -v65, v103, v88
    v_fma_f32 v104, v65, v87, v104
    v_fma_f32 v89, v64, v88, v89
    v_fma_f32 v105, v64, v104, v105
    v_fma_f32 v89, -v65, v104, v89
    v_fma_f32 v105, v65, v88, v105
    v_fma_f32 v90, v64, v89, v90
    v_fma_f32 v106, v64, v105, v106
    v_fma_f32 v90, -v65, v105, v90
    v_fma_f32 v106, v65, v89, v106
    v_fma_f32 v91, v64, v90, v91
    v_fma_f32 v107, v64, v106, v107
    v_fma_f32 v91, -v65, v106, v91
    v_fma_f32 v107, v65, v90, v107
    v_mov_b32 v108, v91
    v_mov_b32 v109, v107
    s_and_b32 s50, s22, 3
    s_lshr_b32 s57, s22, 2
    s_lshl_b32 s57, s57, 11
    s_add_u32 s57, s57, 122880
    s_lshl_b32 s49, s50, 9
    s_add_u32 s49, s49, s57
    v_lshlrev_b32 v110, 3, v1
    v_add_u32 v110, s49, v110
    ds_write_b64 v110, v[108:109]
    v_and_b32 v111, 31, v1
    v_lshlrev_b32 v111, 3, v111
    v_add_u32 v111, s57, v111
    v_cvt_pk_bf16_f32 v112, v76, v77
    v_cvt_pk_bf16_f32 v113, v78, v79
    v_cvt_pk_bf16_f32 v114, v80, v81
    v_cvt_pk_bf16_f32 v115, v82, v83
    v_cvt_pk_bf16_f32 v116, v84, v85
    v_cvt_pk_bf16_f32 v117, v86, v87
    v_cvt_pk_bf16_f32 v118, v88, v89
    v_cvt_pk_bf16_f32 v119, v90, v91
    v_cvt_pk_bf16_f32 v120, v92, v93
    v_cvt_pk_bf16_f32 v121, v94, v95
    v_cvt_pk_bf16_f32 v122, v96, v97
    v_cvt_pk_bf16_f32 v123, v98, v99
    v_cvt_pk_bf16_f32 v124, v100, v101
    v_cvt_pk_bf16_f32 v125, v102, v103
    v_cvt_pk_bf16_f32 v126, v104, v105
    v_cvt_pk_bf16_f32 v127, v106, v107
    s_lshl_b32 s49, s26, 4
    s_add_u32 s49, s49, s25
    s_lshl_b32 s49, s49, 2
    s_add_u32 s49, s49, s50
    s_mov_b32 s58, s49
    s_lshl_b32 s49, s49, 12
    s_add_u32 s49, s49, 6291456
    v_lshlrev_b32 v128, 4, v1
    v_add_u32 v128, s49, v128
    global_store_dwordx4 v128, v[112:115], s[20:21] offset:0 sc0 sc1
    global_store_dwordx4 v128, v[116:119], s[20:21] offset:1024 sc0 sc1
    global_store_dwordx4 v128, v[120:123], s[20:21] offset:2048 sc0 sc1
    global_store_dwordx4 v128, v[124:127], s[20:21] offset:3072 sc0 sc1
    s_waitcnt lgkmcnt(0)
    s_barrier
    ds_read_b64 v[130:131], v111 offset:0
    ds_read_b64 v[132:133], v111 offset:256
    ds_read_b64 v[134:135], v111 offset:512
    ds_read_b64 v[136:137], v111 offset:768
    ds_read_b64 v[138:139], v111 offset:1024
    ds_read_b64 v[140:141], v111 offset:1280
    ds_read_b64 v[142:143], v111 offset:1536
    v_mov_b32 v144, 0
    v_mov_b32 v145, 0
    s_lshl_b32 s49, s50, 1
    s_waitcnt lgkmcnt(0)
    s_cmp_gt_u32 s49, 0
    s_cbranch_scc0 L_k1_cdone
    v_pk_fma_f32 v[146:147], v[144:145], v[68:69], v[130:131] op_sel_hi:[0,1,1]
    v_pk_fma_f32 v[144:145], v[144:145], v[68:69], v[146:147] op_sel:[1,1,0] op_sel_hi:[1,0,1] neg_lo:[0,1,0]
    s_cmp_gt_u32 s49, 1
    s_cbranch_scc0 L_k1_cdone
    v_pk_fma_f32 v[146:147], v[144:145], v[68:69], v[132:133] op_sel_hi:[0,1,1]
    v_pk_fma_f32 v[144:145], v[144:145], v[68:69], v[146:147] op_sel:[1,1,0] op_sel_hi:[1,0,1] neg_lo:[0,1,0]
    s_cmp_gt_u32 s49, 2
    s_cbranch_scc0 L_k1_cdone
    v_pk_fma_f32 v[146:147], v[144:145], v[68:69], v[134:135] op_sel_hi:[0,1,1]
    v_pk_fma_f32 v[144:145], v[144:145], v[68:69], v[146:147] op_sel:[1,1,0] op_sel_hi:[1,0,1] neg_lo:[0,1,0]
    s_cmp_gt_u32 s49, 3
    s_cbranch_scc0 L_k1_cdone
    v_pk_fma_f32 v[146:147], v[144:145], v[68:69], v[136:137] op_sel_hi:[0,1,1]
    v_pk_fma_f32 v[144:145], v[144:145], v[68:69], v[146:147] op_sel:[1,1,0] op_sel_hi:[1,0,1] neg_lo:[0,1,0]
    s_cmp_gt_u32 s49, 4
    s_cbranch_scc0 L_k1_cdone
    v_pk_fma_f32 v[146:147], v[144:145], v[68:69], v[138:139] op_sel_hi:[0,1,1]
    v_pk_fma_f32 v[144:145], v[144:145], v[68:69], v[146:147] op_sel:[1,1,0] op_sel_hi:[1,0,1] neg_lo:[0,1,0]
    s_cmp_gt_u32 s49, 5
    s_cbranch_scc0 L_k1_cdone
    v_pk_fma_f32 v[146:147], v[144:145], v[68:69], v[140:141] op_sel_hi:[0,1,1]
    v_pk_fma_f32 v[144:145], v[144:145], v[68:69], v[146:147] op_sel:[1,1,0] op_sel_hi:[1,0,1] neg_lo:[0,1,0]
L_k1_cdone:
    s_lshl_b32 s49, s50, 9
    v_add_u32 v111, s49, v111
    ds_read_b64 v[148:149], v111
    s_waitcnt lgkmcnt(0)
    v_pk_fma_f32 v[146:147], v[144:145], v[68:69], v[148:149] op_sel_hi:[0,1,1]
    v_pk_fma_f32 v[150:151], v[144:145], v[68:69], v[146:147] op_sel:[1,1,0] op_sel_hi:[1,0,1] neg_lo:[0,1,0]
    v_cmp_lt_u32 vcc, 31, v1
    s_nop 1
    v_cndmask_b32 v144, v144, v150, vcc
    v_cndmask_b32 v145, v145, v151, vcc
    s_lshl_b32 s49, s58, 9
    s_add_u32 s49, s49, 10485760
    v_lshlrev_b32 v128, 3, v1
    v_add_u32 v128, s49, v128
    global_store_dwordx2 v128, v[144:145], s[20:21] sc0 sc1
    s_cmp_eq_u32 s50, 3
    s_cbranch_scc0 L_k1_end
    v_pk_fma_f32 v[146:147], v[144:145], v[68:69], v[108:109] op_sel_hi:[0,1,1]
    v_pk_fma_f32 v[150:151], v[144:145], v[68:69], v[146:147] op_sel:[1,1,0] op_sel_hi:[1,0,1] neg_lo:[0,1,0]
    v_and_b32 v152, 31, v1
    v_lshlrev_b32 v152, 4, v152
    s_lshl_b32 s49, s25, 12
    s_lshr_b32 s50, s26, 1
    s_lshl_b32 s50, s50, 9
    s_add_u32 s49, s49, s50
    s_and_b32 s50, s26, 1
    s_lshl_b32 s50, s50, 3
    s_add_u32 s49, s49, s50
    s_add_u32 s49, s49, 11010048
    v_add_u32 v152, s49, v152
    v_cmp_lt_u32 vcc, 31, v1
    s_and_saveexec_b64 s[56:57], vcc
    global_store_dwordx2 v152, v[150:151], s[20:21] sc0 sc1
L_k1_end:
    s_endpgm
.globl k2_kernel
.p2align 8
.type k2_kernel,@function
k2_kernel:
    s_cmp_ge_u32 s2, 256
    s_cbranch_scc1 L_k2_end
    s_load_dwordx2 s[4:5], s[0:1], 120
    v_lshrrev_b32 v2, 6, v0
    v_and_b32 v1, 63, v0
    s_and_b32 s7, s2, 7
    v_readfirstlane_b32 s6, v2
    s_nop 3
    s_add_u32 s6, s6, 8
    s_cmp_ge_u32 s6, 12
    s_cselect_b32 s20, 12, 0
    s_sub_u32 s6, s6, s20
    s_lshr_b32 s8, s2, 3
    s_and_b32 s9, s8, 3
    s_lshl_b32 s20, s7, 2
    s_add_u32 s9, s9, s20
    v_lshlrev_b32 v3, 4, v1
    s_cmp_ge_u32 s6, 8
    s_cbranch_scc1 L_k2_loader
    s_setprio 3
    s_lshr_b32 s10, s8, 2
    s_lshl_b32 s10, s10, 3
    s_and_b32 s20, s6, 3
    s_lshl_b32 s20, s20, 1
    s_add_u32 s10, s10, s20
    s_lshr_b32 s14, s6, 2
    s_lshl_b32 s20, s9, 16
    s_lshl_b32 s21, s10, 10
    s_add_u32 s21, s21, s20
    v_add_u32 v4, s21, v3
    s_waitcnt lgkmcnt(0)
    global_load_dwordx4 v[8:11], v4, s[4:5]
    global_load_dwordx4 v[12:15], v4, s[4:5] offset:1024
    s_add_u32 s20, s10, s14
    s_lshl_b32 s20, s20, 5
    v_and_b32 v5, 31, v1
    v_add_u32 v5, s20, v5
    v_lshlrev_b32 v5, 3, v5
    v_add_u32 v5, 11091968, v5
    global_load_dword v140, v5, s[4:5]
    v_mov_b32 v136, 0xdddddddd
    v_mov_b32 v139, 157696
    s_mov_b32 s28, 0x0000ffff
    s_mov_b32 s29, 0x0000ffff
    v_and_b32 v5, 27, v1
    v_cmp_eq_u32 vcc, 16, v5
    v_mov_b32 v6, 0x3f803f80
    s_nop 0
    v_cndmask_b32 v5, 0, v6, vcc
    v_mov_b32 v120, v5
    v_mov_b32 v121, v5
    v_mov_b32 v122, v5
    v_mov_b32 v123, v5
    v_mov_b32 v124, v5
    v_mov_b32 v125, v5
    v_mov_b32 v126, v5
    v_mov_b32 v127, v5
    v_mov_b32 v128, v5
    v_mov_b32 v129, v5
    v_mov_b32 v130, v5
    v_mov_b32 v131, v5
    v_mov_b32 v132, v5
    v_mov_b32 v133, v5
    v_mov_b32 v134, v5
    v_mov_b32 v135, v5
    v_mov_b32 v80, 0
    v_mov_b32 v81, 0
    v_mov_b32 v82, 0
    v_mov_b32 v83, 0
    v_mov_b32 v84, 0
    v_mov_b32 v85, 0
    v_mov_b32 v86, 0
    v_mov_b32 v87, 0
    v_mov_b32 v88, 0
    v_mov_b32 v89, 0
    v_mov_b32 v90, 0
    v_mov_b32 v91, 0
    v_mov_b32 v92, 0
    v_mov_b32 v93, 0
    v_mov_b32 v94, 0
    v_mov_b32 v95, 0
    v_mov_b32 v96, 0
    v_mov_b32 v97, 0
    v_mov_b32 v98, 0
    v_mov_b32 v99, 0
    v_mov_b32 v100, 0
    v_mov_b32 v101, 0
    v_mov_b32 v102, 0
    v_mov_b32 v103, 0
    v_mov_b32 v104, 0
    v_mov_b32 v105, 0
    v_mov_b32 v106, 0
    v_mov_b32 v107, 0
    v_mov_b32 v108, 0
    v_mov_b32 v109, 0
    v_mov_b32 v110, 0
    v_mov_b32 v111, 0
    s_lshl_b32 s20, s14, 15
    v_add_u32 v137, s20, v3
    v_and_b32 v4, 15, v1
    v_lshlrev_b32 v4, 4, v4
    v_lshrrev_b32 v5, 5, v1
    v_lshl_add_u32 v4, v5, 8, v4
    s_add_u32 s20, s20, 65536
    v_add_u32 v138, s20, v4
    s_and_b32 s20, s6, 3
    s_lshl_b32 s20, s20, 1
    s_xor_b32 s21, s14, 1
    s_add_u32 s21, s21, s20
    s_mul_i32 s21, s21, 2304
    s_add_u32 s21, s21, 139264
    v_add_u32 v141, s21, v3
    v_lshlrev_b32 v142, 2, v1
    s_add_u32 s21, s21, 2048
    v_add_u32 v142, s21, v142
    s_add_u32 s20, s20, s14
    s_mul_i32 s20, s20, 2304
    s_add_u32 s20, s20, 139264
    v_add_u32 v143, s20, v3
    v_lshlrev_b32 v144, 2, v1
    s_add_u32 s20, s20, 2048
    v_add_u32 v144, s20, v144
    s_waitcnt vmcnt(0)
    s_barrier
    ds_read_b128 v[116:119], v137
    ds_read_b128 v[112:115], v137 offset:1024
    s_mov_b64 exec, s[28:29]
    ds_read_b128 v[120:123], v138
    ds_read_b128 v[124:127], v138 offset:512
    s_mov_b64 exec, -1
    s_waitcnt lgkmcnt(3)
    v_mfma_f32_32x32x16_bf16 v[16:31], v[116:119], v[8:11], 0
    v_mfma_f32_32x32x16_bf16 v[48:63], v[116:119], v[12:15], 0
    s_mov_b32 s22, 0
    s_mov_b32 s23, 1
    s_cmp_eq_u32 s14, 0
    s_cbranch_scc1 L_k2_pa0
    s_setprio 2
    s_branch L_k2_pb0
L_k2_pa0:
    s_setprio 1
L_k2_pb0:
    v_mov_b32 v72, 0
    v_mov_b32 v73, 0
    v_mov_b32 v74, 0
    v_mov_b32 v75, 0
    v_mov_b32 v76, 0
    v_mov_b32 v77, 0
    v_mov_b32 v78, 0
    v_mov_b32 v79, 0
    s_nop 7
    s_branch L_k2_loop
.p2align 6
L_k2_loop:
    s_waitcnt lgkmcnt(0)
    v_exp_f32 v16, v16
    v_exp_f32 v17, v17
    v_smfmac_f32_32x32x32_bf16 v[96:111], v[132:135], v[72:79], v136
    ds_read_b128 v[116:119], v137 offset:2048
    v_exp_f32 v18, v18
    v_exp_f32 v19, v19
    s_mov_b64 exec, s[28:29]
    ds_read_b128 v[128:131], v138 offset:1024
    ds_read_b128 v[132:135], v138 offset:1536
    s_mov_b64 exec, -1
    v_exp_f32 v20, v20
    v_exp_f32 v21, v21
    v_mfma_f32_32x32x16_bf16 v[32:47], v[112:115], v[8:11], 0
    v_exp_f32 v22, v22
    v_exp_f32 v23, v23
    v_exp_f32 v24, v24
    v_exp_f32 v25, v25
    v_smfmac_f32_32x32x32_bf16 v[80:95], v[120:123], v[16:23], v136
    v_exp_f32 v26, v26
    v_exp_f32 v27, v27
    v_exp_f32 v28, v28
    v_exp_f32 v29, v29
    v_mfma_f32_32x32x16_bf16 v[64:79], v[112:115], v[12:15], 0
    v_exp_f32 v30, v30
    v_exp_f32 v31, v31
    v_exp_f32 v48, v48
    v_exp_f32 v49, v49
    v_smfmac_f32_32x32x32_bf16 v[80:95], v[124:127], v[24:31], v136
    v_exp_f32 v50, v50
    v_exp_f32 v51, v51
    v_exp_f32 v52, v52
    v_exp_f32 v53, v53
    v_exp_f32 v54, v54
    v_exp_f32 v55, v55
    v_exp_f32 v56, v56
    v_exp_f32 v57, v57
    v_smfmac_f32_32x32x32_bf16 v[96:111], v[120:123], v[48:55], v136
    v_exp_f32 v58, v58
    v_exp_f32 v59, v59
    v_exp_f32 v60, v60
    v_exp_f32 v61, v61
    v_exp_f32 v62, v62
    v_exp_f32 v63, v63
    s_waitcnt lgkmcnt(0)
    v_exp_f32 v32, v32
    v_exp_f32 v33, v33
    v_smfmac_f32_32x32x32_bf16 v[96:111], v[124:127], v[56:63], v136
    ds_read_b128 v[112:115], v137 offset:3072
    v_exp_f32 v34, v34
    v_exp_f32 v35, v35
    s_mov_b64 exec, s[28:29]
    ds_read_b128 v[120:123], v138 offset:2048
    ds_read_b128 v[124:127], v138 offset:2560
    s_mov_b64 exec, -1
    v_exp_f32 v36, v36
    v_exp_f32 v37, v37
    v_mfma_f32_32x32x16_bf16 v[16:31], v[116:119], v[8:11], 0
    v_exp_f32 v38, v38
    v_exp_f32 v39, v39
    v_exp_f32 v40, v40
    v_exp_f32 v41, v41
    v_smfmac_f32_32x32x32_bf16 v[80:95], v[128:131], v[32:39], v136
    v_exp_f32 v42, v42
    v_exp_f32 v43, v43
    v_exp_f32 v44, v44
    v_exp_f32 v45, v45
    v_mfma_f32_32x32x16_bf16 v[48:63], v[116:119], v[12:15], 0
    v_exp_f32 v46, v46
    v_exp_f32 v47, v47
    v_exp_f32 v64, v64
    v_exp_f32 v65, v65
    v_smfmac_f32_32x32x32_bf16 v[80:95], v[132:135], v[40:47], v136
    v_exp_f32 v66, v66
    v_exp_f32 v67, v67
    v_exp_f32 v68, v68
    v_exp_f32 v69, v69
    v_exp_f32 v70, v70
    v_exp_f32 v71, v71
    v_exp_f32 v72, v72
    v_exp_f32 v73, v73
    v_smfmac_f32_32x32x32_bf16 v[96:111], v[128:131], v[64:71], v136
    v_exp_f32 v74, v74
    v_exp_f32 v75, v75
    v_exp_f32 v76, v76
    v_exp_f32 v77, v77
    v_exp_f32 v78, v78
    v_exp_f32 v79, v79
    v_add_u32 v137, 2048, v137
    v_add_u32 v138, 2048, v138
    s_add_u32 s22, s22, 1
    s_cmp_lt_u32 s22, s23
    s_cbranch_scc1 L_k2_loop
    s_cmp_eq_u32 s22, 1
    s_cbranch_scc0 L_k2_ev1_skip
    s_mov_b32 s23, 5
L_k2_fl1:
    ds_read_b32 v4, v139 offset:0
    s_waitcnt lgkmcnt(0)
    v_readfirstlane_b32 s20, v4
    s_nop 3
    s_cmp_ge_u32 s20, 4
    s_cbranch_scc1 L_k2_loop
    s_sleep 1
    s_branch L_k2_fl1
L_k2_ev1_skip:
    s_cmp_eq_u32 s22, 5
    s_cbranch_scc0 L_k2_ev5_skip
    s_mov_b32 s23, 13
L_k2_fl5:
    ds_read_b32 v4, v139 offset:4
    s_waitcnt lgkmcnt(0)
    v_readfirstlane_b32 s20, v4
    s_nop 3
    s_cmp_ge_u32 s20, 4
    s_cbranch_scc1 L_k2_loop
    s_sleep 1
    s_branch L_k2_fl5
L_k2_ev5_skip:
    s_cmp_eq_u32 s22, 13
    s_cbranch_scc0 L_k2_ev13_skip
    s_mov_b32 s23, 16
    s_cmp_eq_u32 s14, 0
    s_cbranch_scc1 L_k2_pa13
    s_setprio 0
    s_branch L_k2_pb13
L_k2_pa13:
L_k2_pb13:
    s_branch L_k2_loop
L_k2_ev13_skip:
    s_setprio 0
    v_smfmac_f32_32x32x32_bf16 v[96:111], v[132:135], v[72:79], v136
    s_nop 7
    s_nop 3
    s_cmp_eq_u32 s14, 0
    s_cbranch_scc0 L_k2_x1
    ds_write_b128 v141, v[96:99]
    ds_write_b128 v141, v[100:103] offset:1024
    ds_write_b32 v142, v104
    s_branch L_k2_x2
L_k2_x1:
    ds_write_b128 v141, v[80:83]
    ds_write_b128 v141, v[84:87] offset:1024
    ds_write_b32 v142, v88
    v_mov_b32 v80, v96
    v_mov_b32 v81, v97
    v_mov_b32 v82, v98
    v_mov_b32 v83, v99
    v_mov_b32 v84, v100
    v_mov_b32 v85, v101
    v_mov_b32 v86, v102
    v_mov_b32 v87, v103
    v_mov_b32 v88, v104
    v_mov_b32 v8, v12
    v_mov_b32 v9, v13
    v_mov_b32 v10, v14
    v_mov_b32 v11, v15
L_k2_x2:
    s_add_u32 s10, s10, s14
    s_waitcnt lgkmcnt(0)
    s_barrier
    ds_read_b128 v[16:19], v143
    ds_read_b128 v[20:23], v143 offset:1024
    ds_read_b32 v24, v144
    s_waitcnt lgkmcnt(0)
    v_add_f32 v80, v80, v16
    v_add_f32 v81, v81, v17
    v_add_f32 v82, v82, v18
    v_add_f32 v83, v83, v19
    v_add_f32 v84, v84, v20
    v_add_f32 v85, v85, v21
    v_add_f32 v86, v86, v22
    v_add_f32 v87, v87, v23
    v_add_f32 v88, v88, v24
    v_add_f32 v145, |v80|, |v81|
    v_add_f32 v146, |v82|, |v83|
    v_add_f32 v145, v145, |v84|
    v_add_f32 v146, v146, |v85|
    v_add_f32 v145, v145, |v86|
    v_add_f32 v146, v146, |v87|
    v_add_f32 v145, v145, v146
    v_cmp_ge_f32 vcc, 0x7b800000, v145
    s_mov_b32 s20, 0x21800000
    s_mov_b32 s21, 0x5d800000
    v_cmp_le_f32 s[32:33], s20, v88
    v_cmp_ge_f32 s[34:35], s21, v88
    s_nop 1
    s_and_b64 vcc, vcc, s[32:33]
    s_and_b64 vcc, vcc, s[34:35]
    s_cmp_eq_u64 vcc, exec
    s_cbranch_scc0 L_k2_slow
L_k2_fin:
    v_rcp_f32 v145, v88
    s_mul_i32 s20, s10, 96
    s_add_u32 s20, s20, s9
    s_lshl_b32 s20, s20, 10
    s_add_u32 s20, s20, 11534336
    v_add_u32 v146, s20, v3
    s_nop 0
    v_mul_f32 v145, v145, v140
    v_mul_f32 v80, v80, v145
    v_mul_f32 v81, v81, v145
    v_mul_f32 v82, v82, v145
    v_mul_f32 v83, v83, v145
    v_mul_f32 v84, v84, v145
    v_mul_f32 v85, v85, v145
    v_mul_f32 v86, v86, v145
    v_mul_f32 v87, v87, v145
    v_cvt_pk_bf16_f32 v148, v80, v81
    v_cvt_pk_bf16_f32 v149, v82, v83
    v_cvt_pk_bf16_f32 v150, v84, v85
    v_cvt_pk_bf16_f32 v151, v86, v87
    global_store_dwordx4 v146, v[148:151], s[4:5] sc1
    s_endpgm
L_k2_slow:
    v_mov_b32 v145, 0xff800000
    s_lshl_b32 s20, s9, 16
    s_add_u32 s20, s20, 2097152
    v_add_u32 v137, s20, v3
    s_mov_b32 s22, 64
L_k2_mx:
    global_load_dwordx4 v[112:115], v137, s[4:5]
    v_add_u32 v137, 1024, v137
    s_waitcnt vmcnt(0)
    v_mfma_f32_32x32x16_bf16 v[16:31], v[112:115], v[8:11], 0
    s_nop 7
    s_nop 7
    v_max3_f32 v145, v16, v17, v145
    v_max3_f32 v145, v18, v19, v145
    v_max3_f32 v145, v20, v21, v145
    v_max3_f32 v145, v22, v23, v145
    v_max3_f32 v145, v24, v25, v145
    v_max3_f32 v145, v26, v27, v145
    v_max3_f32 v145, v28, v29, v145
    v_max3_f32 v145, v30, v31, v145
    s_sub_u32 s22, s22, 1
    s_cmp_lg_u32 s22, 0
    s_cbranch_scc1 L_k2_mx
    v_mov_b32 v146, v145
    s_nop 1
    v_permlane32_swap_b32 v145, v146
    s_nop 1
    v_max_f32 v145, v145, v146
    v_sub_f32 v32, 0, v145
    v_sub_f32 v33, 0, v145
    v_sub_f32 v34, 0, v145
    v_sub_f32 v35, 0, v145
    v_sub_f32 v36, 0, v145
    v_sub_f32 v37, 0, v145
    v_sub_f32 v38, 0, v145
    v_sub_f32 v39, 0, v145
    v_sub_f32 v40, 0, v145
    v_sub_f32 v41, 0, v145
    v_sub_f32 v42, 0, v145
    v_sub_f32 v43, 0, v145
    v_sub_f32 v44, 0, v145
    v_sub_f32 v45, 0, v145
    v_sub_f32 v46, 0, v145
    v_sub_f32 v47, 0, v145
    v_mov_b32 v80, 0
    v_mov_b32 v81, 0
    v_mov_b32 v82, 0
    v_mov_b32 v83, 0
    v_mov_b32 v84, 0
    v_mov_b32 v85, 0
    v_mov_b32 v86, 0
    v_mov_b32 v87, 0
    v_mov_b32 v88, 0
    v_mov_b32 v89, 0
    v_mov_b32 v90, 0
    v_mov_b32 v91, 0
    v_mov_b32 v92, 0
    v_mov_b32 v93, 0
    v_mov_b32 v94, 0
    v_mov_b32 v95, 0
    s_lshl_b32 s20, s9, 16
    s_add_u32 s21, s20, 2097152
    v_add_u32 v137, s21, v3
    v_and_b32 v4, 15, v1
    v_lshlrev_b32 v4, 4, v4
    v_lshrrev_b32 v5, 5, v1
    v_lshl_add_u32 v4, v5, 8, v4
    s_add_u32 s21, s20, 4194304
    v_add_u32 v138, s21, v4
    s_mov_b32 s22, 64
L_k2_sl:
    global_load_dwordx4 v[112:115], v137, s[4:5]
    s_mov_b64 exec, s[28:29]
    global_load_dwordx4 v[120:123], v138, s[4:5]
    global_load_dwordx4 v[124:127], v138, s[4:5] offset:512
    s_mov_b64 exec, -1
    v_add_u32 v137, 1024, v137
    v_add_u32 v138, 1024, v138
    s_waitcnt vmcnt(0)
    v_mfma_f32_32x32x16_bf16 v[16:31], v[112:115], v[8:11], v[32:47]
    s_nop 7
    s_nop 7
    v_exp_f32 v16, v16
    v_exp_f32 v17, v17
    v_exp_f32 v18, v18
    v_exp_f32 v19, v19
    v_exp_f32 v20, v20
    v_exp_f32 v21, v21
    v_exp_f32 v22, v22
    v_exp_f32 v23, v23
    v_exp_f32 v24, v24
    v_exp_f32 v25, v25
    v_exp_f32 v26, v26
    v_exp_f32 v27, v27
    v_exp_f32 v28, v28
    v_exp_f32 v29, v29
    v_exp_f32 v30, v30
    v_exp_f32 v31, v31
    s_nop 1
    v_smfmac_f32_32x32x32_bf16 v[80:95], v[120:123], v[16:23], v136
    v_smfmac_f32_32x32x32_bf16 v[80:95], v[124:127], v[24:31], v136
    s_nop 7
    s_nop 7
    s_sub_u32 s22, s22, 1
    s_cmp_lg_u32 s22, 0
    s_cbranch_scc1 L_k2_sl
    s_branch L_k2_fin
L_k2_loader:
    s_load_dwordx2 s[36:37], s[0:1], 0
    s_load_dwordx2 s[38:39], s[0:1], 16
    s_load_dwordx2 s[40:41], s[0:1], 88
    s_load_dwordx2 s[42:43], s[0:1], 104
    s_sub_u32 s13, s6, 8
    s_lshl_b32 s25, s13, 10
    s_lshl_b32 s20, s9, 16
    s_add_u32 s26, s20, s25
    v_mov_b32 v4, 157696
    v_mov_b32 v6, 0
    v_mov_b32 v7, 0
    s_waitcnt lgkmcnt(0)
    s_add_u32 s16, s4, 2097152
    s_addc_u32 s17, s5, 0
    s_and_b32 s17, s17, 0xffff
    s_mov_b32 s18, 0x400000
    s_mov_b32 s19, 0x20000
    s_add_u32 m0, s25, 0
    s_add_u32 s20, s26, 0
    buffer_load_dwordx4 v3, s[16:19], s20 offen lds
    s_add_u32 m0, s25, 65536
    s_add_u32 s20, s26, 2097152
    buffer_load_dwordx4 v3, s[16:19], s20 offen lds
    s_add_u32 m0, s25, 32768
    s_add_u32 s20, s26, 32768
    buffer_load_dwordx4 v3, s[16:19], s20 offen lds
    s_add_u32 m0, s25, 98304
    s_add_u32 s20, s26, 2129920
    buffer_load_dwordx4 v3, s[16:19], s20 offen lds
    s_add_u32 s25, s25, 4096
    s_add_u32 s26, s26, 4096
    s_add_u32 m0, s25, 0
    s_add_u32 s20, s26, 0
    buffer_load_dwordx4 v3, s[16:19], s20 offen lds
    s_add_u32 m0, s25, 65536
    s_add_u32 s20, s26, 2097152
    buffer_load_dwordx4 v3, s[16:19], s20 offen lds
    s_add_u32 m0, s25, 32768
    s_add_u32 s20, s26, 32768
    buffer_load_dwordx4 v3, s[16:19], s20 offen lds
    s_add_u32 m0, s25, 98304
    s_add_u32 s20, s26, 2129920
    buffer_load_dwordx4 v3, s[16:19], s20 offen lds
    s_add_u32 s25, s25, 4096
    s_add_u32 s26, s26, 4096
    ds_write_b64 v4, v[6:7]
    ds_write_b64 v4, v[6:7] offset:8
    v_mov_b32 v5, 1
    s_waitcnt vmcnt(4) lgkmcnt(0)
    s_barrier
    s_add_u32 m0, s25, 0
    s_add_u32 s20, s26, 0
    buffer_load_dwordx4 v3, s[16:19], s20 offen lds
    s_add_u32 m0, s25, 65536
    s_add_u32 s20, s26, 2097152
    buffer_load_dwordx4 v3, s[16:19], s20 offen lds
    s_add_u32 m0, s25, 32768
    s_add_u32 s20, s26, 32768
    buffer_load_dwordx4 v3, s[16:19], s20 offen lds
    s_add_u32 m0, s25, 98304
    s_add_u32 s20, s26, 2129920
    buffer_load_dwordx4 v3, s[16:19], s20 offen lds
    s_add_u32 s25, s25, 4096
    s_add_u32 s26, s26, 4096
    s_add_u32 m0, s25, 0
    s_add_u32 s20, s26, 0
    buffer_load_dwordx4 v3, s[16:19], s20 offen lds
    s_add_u32 m0, s25, 65536
    s_add_u32 s20, s26, 2097152
    buffer_load_dwordx4 v3, s[16:19], s20 offen lds
    s_add_u32 m0, s25, 32768
    s_add_u32 s20, s26, 32768
    buffer_load_dwordx4 v3, s[16:19], s20 offen lds
    s_add_u32 m0, s25, 98304
    s_add_u32 s20, s26, 2129920
    buffer_load_dwordx4 v3, s[16:19], s20 offen lds
    s_add_u32 s25, s25, 4096
    s_add_u32 s26, s26, 4096
    s_waitcnt vmcnt(4)
    s_mov_b64 exec, 1
    ds_add_u32 v4, v5 offset:0
    s_mov_b64 exec, -1
    s_mov_b32 s22, 4
L_k2_dmaloop:
    s_add_u32 m0, s25, 0
    s_add_u32 s20, s26, 0
    buffer_load_dwordx4 v3, s[16:19], s20 offen lds
    s_add_u32 m0, s25, 65536
    s_add_u32 s20, s26, 2097152
    buffer_load_dwordx4 v3, s[16:19], s20 offen lds
    s_add_u32 m0, s25, 32768
    s_add_u32 s20, s26, 32768
    buffer_load_dwordx4 v3, s[16:19], s20 offen lds
    s_add_u32 m0, s25, 98304
    s_add_u32 s20, s26, 2129920
    buffer_load_dwordx4 v3, s[16:19], s20 offen lds
    s_add_u32 s25, s25, 4096
    s_add_u32 s26, s26, 4096
    s_sub_u32 s22, s22, 1
    s_cmp_lg_u32 s22, 0
    s_cbranch_scc1 L_k2_dmaloop
    s_waitcnt vmcnt(0)
    s_mov_b64 exec, 1
    ds_add_u32 v4, v5 offset:4
    s_mov_b64 exec, -1
    s_setprio 3
    s_lshr_b32 s11, s8, 4
    s_lshl_b32 s20, s7, 1
    s_add_u32 s11, s11, s20
    s_and_b32 s12, s8, 15
    v_and_b32 v4, 31, v1
    s_lshl_b32 s20, s12, 5
    v_add_u32 v5, s20, v4
    v_lshlrev_b32 v5, 5, v5
    v_add_u32 v5, 11075584, v5
    global_load_dwordx4 v[8:11], v5, s[4:5]
    global_load_dwordx2 v[12:13], v5, s[4:5] offset:16
    s_lshl_b32 s20, s11, 4
    s_add_u32 s20, s20, s12
    s_lshl_b32 s20, s20, 2
    s_add_u32 s20, s20, s13
    s_lshl_b32 s21, s20, 9
    s_add_u32 s21, s21, 10485760
    v_lshlrev_b32 v5, 3, v1
    v_add_u32 v5, s21, v5
    global_load_dwordx2 v[48:49], v5, s[4:5]
    s_lshl_b32 s21, s20, 12
    s_add_u32 s21, s21, 6291456
    v_add_u32 v5, s21, v3
    global_load_dwordx4 v[52:55], v5, s[4:5] offset:0
    global_load_dwordx4 v[56:59], v5, s[4:5] offset:1024
    global_load_dwordx4 v[60:63], v5, s[4:5] offset:2048
    global_load_dwordx4 v[64:67], v5, s[4:5] offset:3072
    v_lshlrev_b32 v5, 4, v4
    s_lshl_b32 s20, s12, 12
    s_add_u32 s20, s20, 11010048
    v_add_u32 v5, s20, v5
    s_cmp_gt_u32 s11, 0
    s_cbranch_scc0 L_k2_epd
    global_load_dwordx4 v[16:19], v5, s[4:5] offset:0
    s_cmp_gt_u32 s11, 2
    s_cbranch_scc0 L_k2_epd
    global_load_dwordx4 v[20:23], v5, s[4:5] offset:512
    s_cmp_gt_u32 s11, 4
    s_cbranch_scc0 L_k2_epd
    global_load_dwordx4 v[24:27], v5, s[4:5] offset:1024
    s_cmp_gt_u32 s11, 6
    s_cbranch_scc0 L_k2_epd
    global_load_dwordx4 v[28:31], v5, s[4:5] offset:1536
    s_cmp_gt_u32 s11, 8
    s_cbranch_scc0 L_k2_epd
    global_load_dwordx4 v[32:35], v5, s[4:5] offset:2048
    s_cmp_gt_u32 s11, 10
    s_cbranch_scc0 L_k2_epd
    global_load_dwordx4 v[36:39], v5, s[4:5] offset:2560
    s_cmp_gt_u32 s11, 12
    s_cbranch_scc0 L_k2_epd
    global_load_dwordx4 v[40:43], v5, s[4:5] offset:3072
    s_cmp_gt_u32 s11, 14
    s_cbranch_scc0 L_k2_epd
    global_load_dwordx4 v[44:47], v5, s[4:5] offset:3584
L_k2_epd:
    s_waitcnt vmcnt(0)
    v_mov_b32 v68, 0
    v_mov_b32 v69, 0
    s_cmp_gt_u32 s11, 0
    s_cbranch_scc0 L_k2_sdone
    v_pk_fma_f32 v[70:71], v[68:69], v[12:13], v[16:17] op_sel_hi:[0,1,1]
    v_pk_fma_f32 v[68:69], v[68:69], v[12:13], v[70:71] op_sel:[1,1,0] op_sel_hi:[1,0,1] neg_lo:[0,1,0]
    s_cmp_gt_u32 s11, 1
    s_cbranch_scc0 L_k2_sdone
    v_pk_fma_f32 v[70:71], v[68:69], v[12:13], v[18:19] op_sel_hi:[0,1,1]
    v_pk_fma_f32 v[68:69], v[68:69], v[12:13], v[70:71] op_sel:[1,1,0] op_sel_hi:[1,0,1] neg_lo:[0,1,0]
    s_cmp_gt_u32 s11, 2
    s_cbranch_scc0 L_k2_sdone
    v_pk_fma_f32 v[70:71], v[68:69], v[12:13], v[20:21] op_sel_hi:[0,1,1]
    v_pk_fma_f32 v[68:69], v[68:69], v[12:13], v[70:71] op_sel:[1,1,0] op_sel_hi:[1,0,1] neg_lo:[0,1,0]
    s_cmp_gt_u32 s11, 3
    s_cbranch_scc0 L_k2_sdone
    v_pk_fma_f32 v[70:71], v[68:69], v[12:13], v[22:23] op_sel_hi:[0,1,1]
    v_pk_fma_f32 v[68:69], v[68:69], v[12:13], v[70:71] op_sel:[1,1,0] op_sel_hi:[1,0,1] neg_lo:[0,1,0]
    s_cmp_gt_u32 s11, 4
    s_cbranch_scc0 L_k2_sdone
    v_pk_fma_f32 v[70:71], v[68:69], v[12:13], v[24:25] op_sel_hi:[0,1,1]
    v_pk_fma_f32 v[68:69], v[68:69], v[12:13], v[70:71] op_sel:[1,1,0] op_sel_hi:[1,0,1] neg_lo:[0,1,0]
    s_cmp_gt_u32 s11, 5
    s_cbranch_scc0 L_k2_sdone
    v_pk_fma_f32 v[70:71], v[68:69], v[12:13], v[26:27] op_sel_hi:[0,1,1]
    v_pk_fma_f32 v[68:69], v[68:69], v[12:13], v[70:71] op_sel:[1,1,0] op_sel_hi:[1,0,1] neg_lo:[0,1,0]
    s_cmp_gt_u32 s11, 6
    s_cbranch_scc0 L_k2_sdone
    v_pk_fma_f32 v[70:71], v[68:69], v[12:13], v[28:29] op_sel_hi:[0,1,1]
    v_pk_fma_f32 v[68:69], v[68:69], v[12:13], v[70:71] op_sel:[1,1,0] op_sel_hi:[1,0,1] neg_lo:[0,1,0]
    s_cmp_gt_u32 s11, 7
    s_cbranch_scc0 L_k2_sdone
    v_pk_fma_f32 v[70:71], v[68:69], v[12:13], v[30:31] op_sel_hi:[0,1,1]
    v_pk_fma_f32 v[68:69], v[68:69], v[12:13], v[70:71] op_sel:[1,1,0] op_sel_hi:[1,0,1] neg_lo:[0,1,0]
    s_cmp_gt_u32 s11, 8
    s_cbranch_scc0 L_k2_sdone
    v_pk_fma_f32 v[70:71], v[68:69], v[12:13], v[32:33] op_sel_hi:[0,1,1]
    v_pk_fma_f32 v[68:69], v[68:69], v[12:13], v[70:71] op_sel:[1,1,0] op_sel_hi:[1,0,1] neg_lo:[0,1,0]
    s_cmp_gt_u32 s11, 9
    s_cbranch_scc0 L_k2_sdone
    v_pk_fma_f32 v[70:71], v[68:69], v[12:13], v[34:35] op_sel_hi:[0,1,1]
    v_pk_fma_f32 v[68:69], v[68:69], v[12:13], v[70:71] op_sel:[1,1,0] op_sel_hi:[1,0,1] neg_lo:[0,1,0]
    s_cmp_gt_u32 s11, 10
    s_cbranch_scc0 L_k2_sdone
    v_pk_fma_f32 v[70:71], v[68:69], v[12:13], v[36:37] op_sel_hi:[0,1,1]
    v_pk_fma_f32 v[68:69], v[68:69], v[12:13], v[70:71] op_sel:[1,1,0] op_sel_hi:[1,0,1] neg_lo:[0,1,0]
    s_cmp_gt_u32 s11, 11
    s_cbranch_scc0 L_k2_sdone
    v_pk_fma_f32 v[70:71], v[68:69], v[12:13], v[38:39] op_sel_hi:[0,1,1]
    v_pk_fma_f32 v[68:69], v[68:69], v[12:13], v[70:71] op_sel:[1,1,0] op_sel_hi:[1,0,1] neg_lo:[0,1,0]
    s_cmp_gt_u32 s11, 12
    s_cbranch_scc0 L_k2_sdone
    v_pk_fma_f32 v[70:71], v[68:69], v[12:13], v[40:41] op_sel_hi:[0,1,1]
    v_pk_fma_f32 v[68:69], v[68:69], v[12:13], v[70:71] op_sel:[1,1,0] op_sel_hi:[1,0,1] neg_lo:[0,1,0]
    s_cmp_gt_u32 s11, 13
    s_cbranch_scc0 L_k2_sdone
    v_pk_fma_f32 v[70:71], v[68:69], v[12:13], v[42:43] op_sel_hi:[0,1,1]
    v_pk_fma_f32 v[68:69], v[68:69], v[12:13], v[70:71] op_sel:[1,1,0] op_sel_hi:[1,0,1] neg_lo:[0,1,0]
    s_cmp_gt_u32 s11, 14
    s_cbranch_scc0 L_k2_sdone
    v_pk_fma_f32 v[70:71], v[68:69], v[12:13], v[44:45] op_sel_hi:[0,1,1]
    v_pk_fma_f32 v[68:69], v[68:69], v[12:13], v[70:71] op_sel:[1,1,0] op_sel_hi:[1,0,1] neg_lo:[0,1,0]
L_k2_sdone:
    s_lshl_b32 s21, s13, 1
L_k2_pw:
    s_cmp_eq_u32 s21, 0
    s_cbranch_scc1 L_k2_pwd
    v_pk_mul_f32 v[70:71], v[68:69], v[10:11] op_sel_hi:[0,1]
    v_pk_fma_f32 v[68:69], v[68:69], v[10:11], v[70:71] op_sel:[1,1,0] op_sel_hi:[1,0,1] neg_lo:[0,1,0]
    s_sub_u32 s21, s21, 1
    s_branch L_k2_pw
L_k2_pwd:
    v_pk_mul_f32 v[70:71], v[68:69], v[10:11] op_sel_hi:[0,1]
    v_pk_fma_f32 v[72:73], v[68:69], v[10:11], v[70:71] op_sel:[1,1,0] op_sel_hi:[1,0,1] neg_lo:[0,1,0]
    v_cmp_lt_u32 vcc, 31, v1
    s_nop 1
    v_cndmask_b32 v68, v68, v72, vcc
    v_cndmask_b32 v69, v69, v73, vcc
    v_pk_add_f32 v[68:69], v[68:69], v[48:49]
    v_mov_b32 v74, 0x00003f80
    v_mov_b32 v75, 0x3f800000
    v_pk_mul_f32 v[70:71], v[68:69], v[8:9] op_sel_hi:[0,1]
    v_pk_fma_f32 v[68:69], v[68:69], v[8:9], v[70:71] op_sel:[1,1,0] op_sel_hi:[1,0,1] neg_lo:[0,1,0]
    v_dot2_f32_bf16 v16, v52, v74, v68
    v_dot2_f32_bf16 v32, v60, v74, v69
    v_pk_mul_f32 v[70:71], v[68:69], v[8:9] op_sel_hi:[0,1]
    v_pk_fma_f32 v[68:69], v[68:69], v[8:9], v[70:71] op_sel:[1,1,0] op_sel_hi:[1,0,1] neg_lo:[0,1,0]
    v_dot2_f32_bf16 v17, v52, v75, v68
    v_dot2_f32_bf16 v33, v60, v75, v69
    v_pk_mul_f32 v[70:71], v[68:69], v[8:9] op_sel_hi:[0,1]
    v_pk_fma_f32 v[68:69], v[68:69], v[8:9], v[70:71] op_sel:[1,1,0] op_sel_hi:[1,0,1] neg_lo:[0,1,0]
    v_dot2_f32_bf16 v18, v53, v74, v68
    v_dot2_f32_bf16 v34, v61, v74, v69
    v_pk_mul_f32 v[70:71], v[68:69], v[8:9] op_sel_hi:[0,1]
    v_pk_fma_f32 v[68:69], v[68:69], v[8:9], v[70:71] op_sel:[1,1,0] op_sel_hi:[1,0,1] neg_lo:[0,1,0]
    v_dot2_f32_bf16 v19, v53, v75, v68
    v_dot2_f32_bf16 v35, v61, v75, v69
    v_pk_mul_f32 v[70:71], v[68:69], v[8:9] op_sel_hi:[0,1]
    v_pk_fma_f32 v[68:69], v[68:69], v[8:9], v[70:71] op_sel:[1,1,0] op_sel_hi:[1,0,1] neg_lo:[0,1,0]
    v_dot2_f32_bf16 v20, v54, v74, v68
    v_dot2_f32_bf16 v36, v62, v74, v69
    v_pk_mul_f32 v[70:71], v[68:69], v[8:9] op_sel_hi:[0,1]
    v_pk_fma_f32 v[68:69], v[68:69], v[8:9], v[70:71] op_sel:[1,1,0] op_sel_hi:[1,0,1] neg_lo:[0,1,0]
    v_dot2_f32_bf16 v21, v54, v75, v68
    v_dot2_f32_bf16 v37, v62, v75, v69
    v_pk_mul_f32 v[70:71], v[68:69], v[8:9] op_sel_hi:[0,1]
    v_pk_fma_f32 v[68:69], v[68:69], v[8:9], v[70:71] op_sel:[1,1,0] op_sel_hi:[1,0,1] neg_lo:[0,1,0]
    v_dot2_f32_bf16 v22, v55, v74, v68
    v_dot2_f32_bf16 v38, v63, v74, v69
    v_pk_mul_f32 v[70:71], v[68:69], v[8:9] op_sel_hi:[0,1]
    v_pk_fma_f32 v[68:69], v[68:69], v[8:9], v[70:71] op_sel:[1,1,0] op_sel_hi:[1,0,1] neg_lo:[0,1,0]
    v_dot2_f32_bf16 v23, v55, v75, v68
    v_dot2_f32_bf16 v39, v63, v75, v69
    v_pk_mul_f32 v[70:71], v[68:69], v[8:9] op_sel_hi:[0,1]
    v_pk_fma_f32 v[68:69], v[68:69], v[8:9], v[70:71] op_sel:[1,1,0] op_sel_hi:[1,0,1] neg_lo:[0,1,0]
    v_dot2_f32_bf16 v24, v56, v74, v68
    v_dot2_f32_bf16 v40, v64, v74, v69
    v_pk_mul_f32 v[70:71], v[68:69], v[8:9] op_sel_hi:[0,1]
    v_pk_fma_f32 v[68:69], v[68:69], v[8:9], v[70:71] op_sel:[1,1,0] op_sel_hi:[1,0,1] neg_lo:[0,1,0]
    v_dot2_f32_bf16 v25, v56, v75, v68
    v_dot2_f32_bf16 v41, v64, v75, v69
    v_pk_mul_f32 v[70:71], v[68:69], v[8:9] op_sel_hi:[0,1]
    v_pk_fma_f32 v[68:69], v[68:69], v[8:9], v[70:71] op_sel:[1,1,0] op_sel_hi:[1,0,1] neg_lo:[0,1,0]
    v_dot2_f32_bf16 v26, v57, v74, v68
    v_dot2_f32_bf16 v42, v65, v74, v69
    v_pk_mul_f32 v[70:71], v[68:69], v[8:9] op_sel_hi:[0,1]
    v_pk_fma_f32 v[68:69], v[68:69], v[8:9], v[70:71] op_sel:[1,1,0] op_sel_hi:[1,0,1] neg_lo:[0,1,0]
    v_dot2_f32_bf16 v27, v57, v75, v68
    v_dot2_f32_bf16 v43, v65, v75, v69
    v_pk_mul_f32 v[70:71], v[68:69], v[8:9] op_sel_hi:[0,1]
    v_pk_fma_f32 v[68:69], v[68:69], v[8:9], v[70:71] op_sel:[1,1,0] op_sel_hi:[1,0,1] neg_lo:[0,1,0]
    v_dot2_f32_bf16 v28, v58, v74, v68
    v_dot2_f32_bf16 v44, v66, v74, v69
    v_pk_mul_f32 v[70:71], v[68:69], v[8:9] op_sel_hi:[0,1]
    v_pk_fma_f32 v[68:69], v[68:69], v[8:9], v[70:71] op_sel:[1,1,0] op_sel_hi:[1,0,1] neg_lo:[0,1,0]
    v_dot2_f32_bf16 v29, v58, v75, v68
    v_dot2_f32_bf16 v45, v66, v75, v69
    v_pk_mul_f32 v[70:71], v[68:69], v[8:9] op_sel_hi:[0,1]
    v_pk_fma_f32 v[68:69], v[68:69], v[8:9], v[70:71] op_sel:[1,1,0] op_sel_hi:[1,0,1] neg_lo:[0,1,0]
    v_dot2_f32_bf16 v30, v59, v74, v68
    v_dot2_f32_bf16 v46, v67, v74, v69
    v_pk_mul_f32 v[70:71], v[68:69], v[8:9] op_sel_hi:[0,1]
    v_pk_fma_f32 v[68:69], v[68:69], v[8:9], v[70:71] op_sel:[1,1,0] op_sel_hi:[1,0,1] neg_lo:[0,1,0]
    v_dot2_f32_bf16 v31, v59, v75, v68
    v_dot2_f32_bf16 v47, v67, v75, v69
    s_nop 2
    v_cvt_pk_bf16_f32 v76, v16, v17
    v_cvt_pk_bf16_f32 v77, v18, v19
    v_cvt_pk_bf16_f32 v78, v20, v21
    v_cvt_pk_bf16_f32 v79, v22, v23
    v_cvt_pk_bf16_f32 v80, v24, v25
    v_cvt_pk_bf16_f32 v81, v26, v27
    v_cvt_pk_bf16_f32 v82, v28, v29
    v_cvt_pk_bf16_f32 v83, v30, v31
    v_cvt_pk_bf16_f32 v84, -v32, -v33
    v_cvt_pk_bf16_f32 v85, -v34, -v35
    v_cvt_pk_bf16_f32 v86, -v36, -v37
    v_cvt_pk_bf16_f32 v87, -v38, -v39
    v_cvt_pk_bf16_f32 v88, -v40, -v41
    v_cvt_pk_bf16_f32 v89, -v42, -v43
    v_cvt_pk_bf16_f32 v90, -v44, -v45
    v_cvt_pk_bf16_f32 v91, -v46, -v47
    s_lshl_b32 s21, s13, 11
    s_add_u32 s21, s21, 131072
    v_and_b32 v4, 31, v1
    v_lshlrev_b32 v4, 6, v4
    v_lshrrev_b32 v5, 5, v1
    v_lshl_add_u32 v4, v5, 5, v4
    v_add_u32 v92, s21, v4
    ds_write_b128 v92, v[76:79]
    ds_write_b128 v92, v[80:83] offset:16
    v_bfe_u32 v4, v1, 2, 2
    v_lshrrev_b32 v5, 5, v1
    v_lshl_add_u32 v4, v5, 3, v4
    v_lshlrev_b32 v4, 6, v4
    v_and_b32 v5, 3, v1
    v_bfe_u32 v6, v1, 4, 1
    v_lshl_add_u32 v5, v6, 2, v5
    v_lshl_add_u32 v4, v5, 3, v4
    v_add_u32 v93, s21, v4
    s_waitcnt lgkmcnt(0)
    ds_read_b64_tr_b16 v[52:53], v93 offset:0
    ds_read_b64_tr_b16 v[54:55], v93 offset:256
    ds_read_b64_tr_b16 v[56:57], v93 offset:1024
    ds_read_b64_tr_b16 v[58:59], v93 offset:1280
    s_waitcnt lgkmcnt(0)
    ds_write_b128 v92, v[84:87]
    ds_write_b128 v92, v[88:91] offset:16
    s_waitcnt lgkmcnt(0)
    ds_read_b64_tr_b16 v[60:61], v93 offset:0
    ds_read_b64_tr_b16 v[62:63], v93 offset:256
    ds_read_b64_tr_b16 v[64:65], v93 offset:1024
    ds_read_b64_tr_b16 v[66:67], v93 offset:1280
    s_lshl_b32 s21, s11, 2
    s_add_u32 s21, s21, s13
    s_mul_i32 s21, s21, 96
    s_lshl_b32 s20, s12, 1
    s_add_u32 s21, s21, s20
    s_add_u32 s21, s21, 32
    s_lshl_b32 s21, s21, 10
    s_add_u32 s21, s21, 11534336
    v_add_u32 v4, s21, v3
    v_add_u32 v5, 32768, v4
    s_waitcnt lgkmcnt(0)
    global_store_dwordx4 v4, v[52:55], s[4:5] sc1
    global_store_dwordx4 v4, v[56:59], s[4:5] offset:1024 sc1
    global_store_dwordx4 v5, v[60:63], s[4:5] sc1
    global_store_dwordx4 v5, v[64:67], s[4:5] offset:1024 sc1
    s_waitcnt vmcnt(0)
    v_mov_b32 v4, 157696
    v_mov_b32 v5, 1
    s_mov_b64 exec, 1
    ds_add_rtn_u32 v6, v4, v5 offset:8
    s_waitcnt lgkmcnt(0)
    v_readfirstlane_b32 s20, v6
    s_mov_b64 exec, -1
    s_nop 3
    s_cmp_eq_u32 s20, 3
    s_cbranch_scc0 L_k2_nopub
    s_lshl_b32 s20, s11, 8
    s_add_u32 s20, s20, 18874368
    v_mov_b32 v4, s20
    s_mov_b64 exec, 1
    global_atomic_add v4, v5, s[4:5]
    s_mov_b64 exec, -1
L_k2_nopub:
    s_and_b32 s48, s8, 3
    s_lshl_b32 s20, s7, 2
    s_add_u32 s48, s48, s20
    s_lshr_b32 s49, s8, 2
    s_mul_i32 s51, s48, 196608
    s_lshl_b32 s20, s13, 14
    s_add_u32 s51, s51, s20
    s_add_u32 s51, s51, 11567104
    s_lshl_b32 s50, s49, 17
    s_add_u32 s50, s50, s20
    s_add_u32 s50, s50, 17825792
    s_mov_b32 s44, s4
    s_and_b32 s45, s5, 0xffff
    s_mov_b32 s46, 0x2000000
    s_mov_b32 s47, 0x20000
    s_add_u32 s20, s50, 0
    buffer_load_dwordx4 v[72:75], v3, s[44:47], s20 offen
    s_add_u32 s20, s50, 65536
    buffer_load_dwordx4 v[76:79], v3, s[44:47], s20 offen
    s_add_u32 s20, s50, 1024
    buffer_load_dwordx4 v[88:91], v3, s[44:47], s20 offen
    s_add_u32 s20, s50, 66560
    buffer_load_dwordx4 v[92:95], v3, s[44:47], s20 offen
    s_add_u32 s20, s50, 2048
    buffer_load_dwordx4 v[104:107], v3, s[44:47], s20 offen
    s_add_u32 s20, s50, 67584
    buffer_load_dwordx4 v[108:111], v3, s[44:47], s20 offen
    s_add_u32 s20, s50, 3072
    buffer_load_dwordx4 v[120:123], v3, s[44:47], s20 offen
    s_add_u32 s20, s50, 68608
    buffer_load_dwordx4 v[124:127], v3, s[44:47], s20 offen
    s_lshr_b32 s20, s48, 1
    s_lshl_b32 s20, s20, 8
    s_add_u32 s20, s20, 18874368
    v_mov_b32 v4, s20
    s_mov_b32 s54, 0x40000
L_k2_poll:
    global_load_dword v5, v4, s[4:5] sc1
    s_waitcnt vmcnt(0)
    v_readfirstlane_b32 s20, v5
    s_nop 3
    s_cmp_ge_u32 s20, 16
    s_cbranch_scc1 L_k2_polld
    s_sleep 4
    s_sub_u32 s54, s54, 1
    s_cmp_lg_u32 s54, 0
    s_cbranch_scc1 L_k2_poll
L_k2_polld:
    s_setprio 0
    s_add_u32 s20, s51, 0
    buffer_load_dwordx4 v[80:83], v3, s[44:47], s20 offen sc1
    s_add_u32 s20, s51, 98304
    buffer_load_dwordx4 v[84:87], v3, s[44:47], s20 offen sc1
    s_add_u32 s20, s51, 1024
    buffer_load_dwordx4 v[96:99], v3, s[44:47], s20 offen sc1
    s_add_u32 s20, s51, 99328
    buffer_load_dwordx4 v[100:103], v3, s[44:47], s20 offen sc1
    s_add_u32 s20, s51, 2048
    buffer_load_dwordx4 v[112:115], v3, s[44:47], s20 offen sc1
    s_add_u32 s20, s51, 100352
    buffer_load_dwordx4 v[116:119], v3, s[44:47], s20 offen sc1
    s_add_u32 s20, s51, 3072
    buffer_load_dwordx4 v[128:131], v3, s[44:47], s20 offen sc1
    s_add_u32 s20, s51, 101376
    buffer_load_dwordx4 v[132:135], v3, s[44:47], s20 offen sc1
    s_waitcnt vmcnt(0)
    v_mfma_f32_32x32x16_bf16 v[8:23], v[72:75], v[80:83], 0
    v_mfma_f32_32x32x16_bf16 v[24:39], v[76:79], v[80:83], 0
    v_mfma_f32_32x32x16_bf16 v[40:55], v[72:75], v[84:87], 0
    v_mfma_f32_32x32x16_bf16 v[56:71], v[76:79], v[84:87], 0
    s_add_u32 s20, s50, 4096
    buffer_load_dwordx4 v[72:75], v3, s[44:47], s20 offen
    s_add_u32 s20, s50, 69632
    buffer_load_dwordx4 v[76:79], v3, s[44:47], s20 offen
    s_add_u32 s20, s51, 4096
    buffer_load_dwordx4 v[80:83], v3, s[44:47], s20 offen sc1
    s_add_u32 s20, s51, 102400
    buffer_load_dwordx4 v[84:87], v3, s[44:47], s20 offen sc1
    s_waitcnt vmcnt(12)
    v_mfma_f32_32x32x16_bf16 v[8:23], v[88:91], v[96:99], v[8:23]
    v_mfma_f32_32x32x16_bf16 v[24:39], v[92:95], v[96:99], v[24:39]
    v_mfma_f32_32x32x16_bf16 v[40:55], v[88:91], v[100:103], v[40:55]
    v_mfma_f32_32x32x16_bf16 v[56:71], v[92:95], v[100:103], v[56:71]
    s_add_u32 s20, s50, 5120
    buffer_load_dwordx4 v[88:91], v3, s[44:47], s20 offen
    s_add_u32 s20, s50, 70656
    buffer_load_dwordx4 v[92:95], v3, s[44:47], s20 offen
    s_add_u32 s20, s51, 5120
    buffer_load_dwordx4 v[96:99], v3, s[44:47], s20 offen sc1
    s_add_u32 s20, s51, 103424
    buffer_load_dwordx4 v[100:103], v3, s[44:47], s20 offen sc1
    s_waitcnt vmcnt(12)
    v_mfma_f32_32x32x16_bf16 v[8:23], v[104:107], v[112:115], v[8:23]
    v_mfma_f32_32x32x16_bf16 v[24:39], v[108:111], v[112:115], v[24:39]
    v_mfma_f32_32x32x16_bf16 v[40:55], v[104:107], v[116:119], v[40:55]
    v_mfma_f32_32x32x16_bf16 v[56:71], v[108:111], v[116:119], v[56:71]
    s_add_u32 s20, s50, 6144
    buffer_load_dwordx4 v[104:107], v3, s[44:47], s20 offen
    s_add_u32 s20, s50, 71680
    buffer_load_dwordx4 v[108:111], v3, s[44:47], s20 offen
    s_add_u32 s20, s51, 6144
    buffer_load_dwordx4 v[112:115], v3, s[44:47], s20 offen sc1
    s_add_u32 s20, s51, 104448
    buffer_load_dwordx4 v[116:119], v3, s[44:47], s20 offen sc1
    s_waitcnt vmcnt(12)
    v_mfma_f32_32x32x16_bf16 v[8:23], v[120:123], v[128:131], v[8:23]
    v_mfma_f32_32x32x16_bf16 v[24:39], v[124:127], v[128:131], v[24:39]
    v_mfma_f32_32x32x16_bf16 v[40:55], v[120:123], v[132:135], v[40:55]
    v_mfma_f32_32x32x16_bf16 v[56:71], v[124:127], v[132:135], v[56:71]
    s_add_u32 s20, s50, 7168
    buffer_load_dwordx4 v[120:123], v3, s[44:47], s20 offen
    s_add_u32 s20, s50, 72704
    buffer_load_dwordx4 v[124:127], v3, s[44:47], s20 offen
    s_add_u32 s20, s51, 7168
    buffer_load_dwordx4 v[128:131], v3, s[44:47], s20 offen sc1
    s_add_u32 s20, s51, 105472
    buffer_load_dwordx4 v[132:135], v3, s[44:47], s20 offen sc1
    s_waitcnt vmcnt(12)
    v_mfma_f32_32x32x16_bf16 v[8:23], v[72:75], v[80:83], v[8:23]
    v_mfma_f32_32x32x16_bf16 v[24:39], v[76:79], v[80:83], v[24:39]
    v_mfma_f32_32x32x16_bf16 v[40:55], v[72:75], v[84:87], v[40:55]
    v_mfma_f32_32x32x16_bf16 v[56:71], v[76:79], v[84:87], v[56:71]
    s_add_u32 s20, s50, 8192
    buffer_load_dwordx4 v[72:75], v3, s[44:47], s20 offen
    s_add_u32 s20, s50, 73728
    buffer_load_dwordx4 v[76:79], v3, s[44:47], s20 offen
    s_add_u32 s20, s51, 8192
    buffer_load_dwordx4 v[80:83], v3, s[44:47], s20 offen sc1
    s_add_u32 s20, s51, 106496
    buffer_load_dwordx4 v[84:87], v3, s[44:47], s20 offen sc1
    s_waitcnt vmcnt(12)
    v_mfma_f32_32x32x16_bf16 v[8:23], v[88:91], v[96:99], v[8:23]
    v_mfma_f32_32x32x16_bf16 v[24:39], v[92:95], v[96:99], v[24:39]
    v_mfma_f32_32x32x16_bf16 v[40:55], v[88:91], v[100:103], v[40:55]
    v_mfma_f32_32x32x16_bf16 v[56:71], v[92:95], v[100:103], v[56:71]
    s_add_u32 s20, s50, 9216
    buffer_load_dwordx4 v[88:91], v3, s[44:47], s20 offen
    s_add_u32 s20, s50, 74752
    buffer_load_dwordx4 v[92:95], v3, s[44:47], s20 offen
    s_add_u32 s20, s51, 9216
    buffer_load_dwordx4 v[96:99], v3, s[44:47], s20 offen sc1
    s_add_u32 s20, s51, 107520
    buffer_load_dwordx4 v[100:103], v3, s[44:47], s20 offen sc1
    s_waitcnt vmcnt(12)
    v_mfma_f32_32x32x16_bf16 v[8:23], v[104:107], v[112:115], v[8:23]
    v_mfma_f32_32x32x16_bf16 v[24:39], v[108:111], v[112:115], v[24:39]
    v_mfma_f32_32x32x16_bf16 v[40:55], v[104:107], v[116:119], v[40:55]
    v_mfma_f32_32x32x16_bf16 v[56:71], v[108:111], v[116:119], v[56:71]
    s_add_u32 s20, s50, 10240
    buffer_load_dwordx4 v[104:107], v3, s[44:47], s20 offen
    s_add_u32 s20, s50, 75776
    buffer_load_dwordx4 v[108:111], v3, s[44:47], s20 offen
    s_add_u32 s20, s51, 10240
    buffer_load_dwordx4 v[112:115], v3, s[44:47], s20 offen sc1
    s_add_u32 s20, s51, 108544
    buffer_load_dwordx4 v[116:119], v3, s[44:47], s20 offen sc1
    s_waitcnt vmcnt(12)
    v_mfma_f32_32x32x16_bf16 v[8:23], v[120:123], v[128:131], v[8:23]
    v_mfma_f32_32x32x16_bf16 v[24:39], v[124:127], v[128:131], v[24:39]
    v_mfma_f32_32x32x16_bf16 v[40:55], v[120:123], v[132:135], v[40:55]
    v_mfma_f32_32x32x16_bf16 v[56:71], v[124:127], v[132:135], v[56:71]
    s_add_u32 s20, s50, 11264
    buffer_load_dwordx4 v[120:123], v3, s[44:47], s20 offen
    s_add_u32 s20, s50, 76800
    buffer_load_dwordx4 v[124:127], v3, s[44:47], s20 offen
    s_add_u32 s20, s51, 11264
    buffer_load_dwordx4 v[128:131], v3, s[44:47], s20 offen sc1
    s_add_u32 s20, s51, 109568
    buffer_load_dwordx4 v[132:135], v3, s[44:47], s20 offen sc1
    s_waitcnt vmcnt(12)
    v_mfma_f32_32x32x16_bf16 v[8:23], v[72:75], v[80:83], v[8:23]
    v_mfma_f32_32x32x16_bf16 v[24:39], v[76:79], v[80:83], v[24:39]
    v_mfma_f32_32x32x16_bf16 v[40:55], v[72:75], v[84:87], v[40:55]
    v_mfma_f32_32x32x16_bf16 v[56:71], v[76:79], v[84:87], v[56:71]
    s_add_u32 s20, s50, 12288
    buffer_load_dwordx4 v[72:75], v3, s[44:47], s20 offen
    s_add_u32 s20, s50, 77824
    buffer_load_dwordx4 v[76:79], v3, s[44:47], s20 offen
    s_add_u32 s20, s51, 12288
    buffer_load_dwordx4 v[80:83], v3, s[44:47], s20 offen sc1
    s_add_u32 s20, s51, 110592
    buffer_load_dwordx4 v[84:87], v3, s[44:47], s20 offen sc1
    s_waitcnt vmcnt(12)
    v_mfma_f32_32x32x16_bf16 v[8:23], v[88:91], v[96:99], v[8:23]
    v_mfma_f32_32x32x16_bf16 v[24:39], v[92:95], v[96:99], v[24:39]
    v_mfma_f32_32x32x16_bf16 v[40:55], v[88:91], v[100:103], v[40:55]
    v_mfma_f32_32x32x16_bf16 v[56:71], v[92:95], v[100:103], v[56:71]
    s_add_u32 s20, s50, 13312
    buffer_load_dwordx4 v[88:91], v3, s[44:47], s20 offen
    s_add_u32 s20, s50, 78848
    buffer_load_dwordx4 v[92:95], v3, s[44:47], s20 offen
    s_add_u32 s20, s51, 13312
    buffer_load_dwordx4 v[96:99], v3, s[44:47], s20 offen sc1
    s_add_u32 s20, s51, 111616
    buffer_load_dwordx4 v[100:103], v3, s[44:47], s20 offen sc1
    s_waitcnt vmcnt(12)
    v_mfma_f32_32x32x16_bf16 v[8:23], v[104:107], v[112:115], v[8:23]
    v_mfma_f32_32x32x16_bf16 v[24:39], v[108:111], v[112:115], v[24:39]
    v_mfma_f32_32x32x16_bf16 v[40:55], v[104:107], v[116:119], v[40:55]
    v_mfma_f32_32x32x16_bf16 v[56:71], v[108:111], v[116:119], v[56:71]
    s_add_u32 s20, s50, 14336
    buffer_load_dwordx4 v[104:107], v3, s[44:47], s20 offen
    s_add_u32 s20, s50, 79872
    buffer_load_dwordx4 v[108:111], v3, s[44:47], s20 offen
    s_add_u32 s20, s51, 14336
    buffer_load_dwordx4 v[112:115], v3, s[44:47], s20 offen sc1
    s_add_u32 s20, s51, 112640
    buffer_load_dwordx4 v[116:119], v3, s[44:47], s20 offen sc1
    s_waitcnt vmcnt(12)
    v_mfma_f32_32x32x16_bf16 v[8:23], v[120:123], v[128:131], v[8:23]
    v_mfma_f32_32x32x16_bf16 v[24:39], v[124:127], v[128:131], v[24:39]
    v_mfma_f32_32x32x16_bf16 v[40:55], v[120:123], v[132:135], v[40:55]
    v_mfma_f32_32x32x16_bf16 v[56:71], v[124:127], v[132:135], v[56:71]
    s_add_u32 s20, s50, 15360
    buffer_load_dwordx4 v[120:123], v3, s[44:47], s20 offen
    s_add_u32 s20, s50, 80896
    buffer_load_dwordx4 v[124:127], v3, s[44:47], s20 offen
    s_add_u32 s20, s51, 15360
    buffer_load_dwordx4 v[128:131], v3, s[44:47], s20 offen sc1
    s_add_u32 s20, s51, 113664
    buffer_load_dwordx4 v[132:135], v3, s[44:47], s20 offen sc1
    s_waitcnt vmcnt(12)
    v_mfma_f32_32x32x16_bf16 v[8:23], v[72:75], v[80:83], v[8:23]
    v_mfma_f32_32x32x16_bf16 v[24:39], v[76:79], v[80:83], v[24:39]
    v_mfma_f32_32x32x16_bf16 v[40:55], v[72:75], v[84:87], v[40:55]
    v_mfma_f32_32x32x16_bf16 v[56:71], v[76:79], v[84:87], v[56:71]
    s_waitcnt vmcnt(8)
    v_mfma_f32_32x32x16_bf16 v[8:23], v[88:91], v[96:99], v[8:23]
    v_mfma_f32_32x32x16_bf16 v[24:39], v[92:95], v[96:99], v[24:39]
    v_mfma_f32_32x32x16_bf16 v[40:55], v[88:91], v[100:103], v[40:55]
    v_mfma_f32_32x32x16_bf16 v[56:71], v[92:95], v[100:103], v[56:71]
    s_waitcnt vmcnt(4)
    v_mfma_f32_32x32x16_bf16 v[8:23], v[104:107], v[112:115], v[8:23]
    v_mfma_f32_32x32x16_bf16 v[24:39], v[108:111], v[112:115], v[24:39]
    v_mfma_f32_32x32x16_bf16 v[40:55], v[104:107], v[116:119], v[40:55]
    v_mfma_f32_32x32x16_bf16 v[56:71], v[108:111], v[116:119], v[56:71]
    s_waitcnt vmcnt(0)
    v_mfma_f32_32x32x16_bf16 v[8:23], v[120:123], v[128:131], v[8:23]
    v_mfma_f32_32x32x16_bf16 v[24:39], v[124:127], v[128:131], v[24:39]
    v_mfma_f32_32x32x16_bf16 v[40:55], v[120:123], v[132:135], v[40:55]
    v_mfma_f32_32x32x16_bf16 v[56:71], v[124:127], v[132:135], v[56:71]
    v_and_b32 v5, 31, v1
    s_lshl_b32 s20, s48, 6
    v_add_u32 v5, s20, v5
    v_lshlrev_b32 v5, 3, v5
    v_add_u32 v5, 11091968, v5
    global_load_dwordx2 v[136:137], v5, s[4:5]
    global_load_dwordx2 v[138:139], v5, s[4:5] offset:256
    s_and_b32 s52, s13, 1
    s_lshl_b32 s20, s48, 1
    s_add_u32 s52, s52, s20
    s_lshr_b32 s53, s13, 1
    s_lshl_b32 s20, s49, 1
    s_add_u32 s53, s53, s20
    s_lshl_b32 s38, s53, 5
    v_lshrrev_b32 v4, 5, v1
    v_lshlrev_b32 v4, 4, v4
    v_add_u32 v4, s38, v4
    v_and_b32 v5, 31, v1
    s_lshl_b32 s20, s52, 5
    v_add_u32 v5, s20, v5
    v_lshlrev_b32 v6, 1, v4
    v_lshl_add_u32 v7, v5, 10, v6
    global_load_dwordx4 v[140:143], v7, s[36:37]
    global_load_dwordx4 v[144:147], v7, s[36:37] offset:16
    global_load_dwordx4 v[148:151], v6, s[40:41]
    global_load_dwordx4 v[152:155], v6, s[40:41] offset:16
    s_lshl_b32 s21, s49, 16
    s_lshl_b32 s20, s13, 14
    s_add_u32 s21, s21, s20
    s_add_u32 s21, s21, 19398656
    v_lshlrev_b32 v4, 7, v1
    v_add_u32 v4, s21, v4
    global_load_dword v72, v4, s[4:5]
    v_add_u32 v4, 8192, v4
    global_load_dword v73, v4, s[4:5]
    s_setprio 0
    s_lshl_b32 s20, s13, 13
    v_add_u32 v157, s20, v3
    s_mul_i32 s51, s48, 196608
    s_add_u32 s51, s51, s20
    s_add_u32 s51, s51, 11534336
    s_lshr_b32 s20, s48, 2
    s_lshl_b32 s20, s20, 3
    s_lshl_b32 s21, s13, 1
    s_add_u32 s20, s20, s21
    s_add_u32 s20, s20, 16
    s_lshl_b32 s20, s20, 8
    s_add_u32 s55, s20, 18874368
    s_lshl_b32 s21, s49, 16
    s_lshl_b32 s25, s13, 14
    s_add_u32 s21, s21, s25
    s_add_u32 s21, s21, 19398656
    s_mov_b32 s22, 16
    s_waitcnt vmcnt(0)
    s_barrier
    s_setprio 3
L_k2_wo:
    s_mov_b32 m0, s25
    s_add_u32 s25, s25, 1024
    buffer_load_dwordx4 v3, s[44:47], s21 offen lds
    s_add_u32 s21, s21, 1024
    s_sub_u32 s22, s22, 1
    s_cmp_lg_u32 s22, 0
    s_cbranch_scc1 L_k2_wo
    v_add_f32 v136, v137, v137
    v_add_f32 v138, v139, v139
    s_and_b32 s20, s13, 1
    s_cmp_eq_u32 s20, 0
    s_cselect_b64 vcc, -1, 0
    v_cndmask_b32 v156, v139, v137, vcc
    v_mul_f32 v8, v136, v8
    v_mul_f32 v9, v136, v9
    v_mul_f32 v10, v136, v10
    v_mul_f32 v11, v136, v11
    v_mul_f32 v12, v136, v12
    v_mul_f32 v13, v136, v13
    v_mul_f32 v14, v136, v14
    v_mul_f32 v15, v136, v15
    v_mul_f32 v16, v136, v16
    v_mul_f32 v17, v136, v17
    v_mul_f32 v18, v136, v18
    v_mul_f32 v19, v136, v19
    v_mul_f32 v20, v136, v20
    v_mul_f32 v21, v136, v21
    v_mul_f32 v22, v136, v22
    v_mul_f32 v23, v136, v23
    v_mul_f32 v24, v136, v24
    v_mul_f32 v25, v136, v25
    v_mul_f32 v26, v136, v26
    v_mul_f32 v27, v136, v27
    v_mul_f32 v28, v136, v28
    v_mul_f32 v29, v136, v29
    v_mul_f32 v30, v136, v30
    v_mul_f32 v31, v136, v31
    v_mul_f32 v32, v136, v32
    v_mul_f32 v33, v136, v33
    v_mul_f32 v34, v136, v34
    v_mul_f32 v35, v136, v35
    v_mul_f32 v36, v136, v36
    v_mul_f32 v37, v136, v37
    v_mul_f32 v38, v136, v38
    v_mul_f32 v39, v136, v39
    v_mul_f32 v40, v138, v40
    v_mul_f32 v41, v138, v41
    v_mul_f32 v42, v138, v42
    v_mul_f32 v43, v138, v43
    v_mul_f32 v44, v138, v44
    v_mul_f32 v45, v138, v45
    v_mul_f32 v46, v138, v46
    v_mul_f32 v47, v138, v47
    v_mul_f32 v48, v138, v48
    v_mul_f32 v49, v138, v49
    v_mul_f32 v50, v138, v50
    v_mul_f32 v51, v138, v51
    v_mul_f32 v52, v138, v52
    v_mul_f32 v53, v138, v53
    v_mul_f32 v54, v138, v54
    v_mul_f32 v55, v138, v55
    v_mul_f32 v56, v138, v56
    v_mul_f32 v57, v138, v57
    v_mul_f32 v58, v138, v58
    v_mul_f32 v59, v138, v59
    v_mul_f32 v60, v138, v60
    v_mul_f32 v61, v138, v61
    v_mul_f32 v62, v138, v62
    v_mul_f32 v63, v138, v63
    v_mul_f32 v64, v138, v64
    v_mul_f32 v65, v138, v65
    v_mul_f32 v66, v138, v66
    v_mul_f32 v67, v138, v67
    v_mul_f32 v68, v138, v68
    v_mul_f32 v69, v138, v69
    v_mul_f32 v70, v138, v70
    v_mul_f32 v71, v138, v71
    v_lshlrev_b32 v4, 16, v140
    v_and_b32 v5, 0xffff0000, v140
    v_lshlrev_b32 v6, 16, v148
    v_and_b32 v7, 0xffff0000, v148
    v_mul_f32 v4, v4, v6
    v_mul_f32 v5, v5, v7
    v_cvt_pk_bf16_f32 v140, v4, v5
    v_lshlrev_b32 v4, 16, v141
    v_and_b32 v5, 0xffff0000, v141
    v_lshlrev_b32 v6, 16, v149
    v_and_b32 v7, 0xffff0000, v149
    v_mul_f32 v4, v4, v6
    v_mul_f32 v5, v5, v7
    v_cvt_pk_bf16_f32 v141, v4, v5
    v_lshlrev_b32 v4, 16, v142
    v_and_b32 v5, 0xffff0000, v142
    v_lshlrev_b32 v6, 16, v150
    v_and_b32 v7, 0xffff0000, v150
    v_mul_f32 v4, v4, v6
    v_mul_f32 v5, v5, v7
    v_cvt_pk_bf16_f32 v142, v4, v5
    v_lshlrev_b32 v4, 16, v143
    v_and_b32 v5, 0xffff0000, v143
    v_lshlrev_b32 v6, 16, v151
    v_and_b32 v7, 0xffff0000, v151
    v_mul_f32 v4, v4, v6
    v_mul_f32 v5, v5, v7
    v_cvt_pk_bf16_f32 v143, v4, v5
    v_lshlrev_b32 v4, 16, v144
    v_and_b32 v5, 0xffff0000, v144
    v_lshlrev_b32 v6, 16, v152
    v_and_b32 v7, 0xffff0000, v152
    v_mul_f32 v4, v4, v6
    v_mul_f32 v5, v5, v7
    v_cvt_pk_bf16_f32 v144, v4, v5
    v_lshlrev_b32 v4, 16, v145
    v_and_b32 v5, 0xffff0000, v145
    v_lshlrev_b32 v6, 16, v153
    v_and_b32 v7, 0xffff0000, v153
    v_mul_f32 v4, v4, v6
    v_mul_f32 v5, v5, v7
    v_cvt_pk_bf16_f32 v145, v4, v5
    v_lshlrev_b32 v4, 16, v146
    v_and_b32 v5, 0xffff0000, v146
    v_lshlrev_b32 v6, 16, v154
    v_and_b32 v7, 0xffff0000, v154
    v_mul_f32 v4, v4, v6
    v_mul_f32 v5, v5, v7
    v_cvt_pk_bf16_f32 v146, v4, v5
    v_lshlrev_b32 v4, 16, v147
    v_and_b32 v5, 0xffff0000, v147
    v_lshlrev_b32 v6, 16, v155
    v_and_b32 v7, 0xffff0000, v155
    v_mul_f32 v4, v4, v6
    v_mul_f32 v5, v5, v7
    v_cvt_pk_bf16_f32 v147, v4, v5
    s_cmp_eq_u32 s13, 0
    s_cbranch_scc0 L_k2_sk0
    v_lshlrev_b32 v4, 16, v140
    v_and_b32 v5, 0xffff0000, v140
    v_fma_f32 v8, v156, v4, v8
    v_fma_f32 v9, v156, v5, v9
    v_lshlrev_b32 v4, 16, v141
    v_and_b32 v5, 0xffff0000, v141
    v_fma_f32 v10, v156, v4, v10
    v_fma_f32 v11, v156, v5, v11
    v_lshlrev_b32 v4, 16, v142
    v_and_b32 v5, 0xffff0000, v142
    v_fma_f32 v12, v156, v4, v12
    v_fma_f32 v13, v156, v5, v13
    v_lshlrev_b32 v4, 16, v143
    v_and_b32 v5, 0xffff0000, v143
    v_fma_f32 v14, v156, v4, v14
    v_fma_f32 v15, v156, v5, v15
    v_lshlrev_b32 v4, 16, v144
    v_and_b32 v5, 0xffff0000, v144
    v_fma_f32 v16, v156, v4, v16
    v_fma_f32 v17, v156, v5, v17
    v_lshlrev_b32 v4, 16, v145
    v_and_b32 v5, 0xffff0000, v145
    v_fma_f32 v18, v156, v4, v18
    v_fma_f32 v19, v156, v5, v19
    v_lshlrev_b32 v4, 16, v146
    v_and_b32 v5, 0xffff0000, v146
    v_fma_f32 v20, v156, v4, v20
    v_fma_f32 v21, v156, v5, v21
    v_lshlrev_b32 v4, 16, v147
    v_and_b32 v5, 0xffff0000, v147
    v_fma_f32 v22, v156, v4, v22
    v_fma_f32 v23, v156, v5, v23
L_k2_sk0:
    s_cmp_eq_u32 s13, 1
    s_cbranch_scc0 L_k2_sk1
    v_lshlrev_b32 v4, 16, v140
    v_and_b32 v5, 0xffff0000, v140
    v_fma_f32 v40, v156, v4, v40
    v_fma_f32 v41, v156, v5, v41
    v_lshlrev_b32 v4, 16, v141
    v_and_b32 v5, 0xffff0000, v141
    v_fma_f32 v42, v156, v4, v42
    v_fma_f32 v43, v156, v5, v43
    v_lshlrev_b32 v4, 16, v142
    v_and_b32 v5, 0xffff0000, v142
    v_fma_f32 v44, v156, v4, v44
    v_fma_f32 v45, v156, v5, v45
    v_lshlrev_b32 v4, 16, v143
    v_and_b32 v5, 0xffff0000, v143
    v_fma_f32 v46, v156, v4, v46
    v_fma_f32 v47, v156, v5, v47
    v_lshlrev_b32 v4, 16, v144
    v_and_b32 v5, 0xffff0000, v144
    v_fma_f32 v48, v156, v4, v48
    v_fma_f32 v49, v156, v5, v49
    v_lshlrev_b32 v4, 16, v145
    v_and_b32 v5, 0xffff0000, v145
    v_fma_f32 v50, v156, v4, v50
    v_fma_f32 v51, v156, v5, v51
    v_lshlrev_b32 v4, 16, v146
    v_and_b32 v5, 0xffff0000, v146
    v_fma_f32 v52, v156, v4, v52
    v_fma_f32 v53, v156, v5, v53
    v_lshlrev_b32 v4, 16, v147
    v_and_b32 v5, 0xffff0000, v147
    v_fma_f32 v54, v156, v4, v54
    v_fma_f32 v55, v156, v5, v55
L_k2_sk1:
    s_cmp_eq_u32 s13, 2
    s_cbranch_scc0 L_k2_sk2
    v_lshlrev_b32 v4, 16, v140
    v_and_b32 v5, 0xffff0000, v140
    v_fma_f32 v24, v156, v4, v24
    v_fma_f32 v25, v156, v5, v25
    v_lshlrev_b32 v4, 16, v141
    v_and_b32 v5, 0xffff0000, v141
    v_fma_f32 v26, v156, v4, v26
    v_fma_f32 v27, v156, v5, v27
    v_lshlrev_b32 v4, 16, v142
    v_and_b32 v5, 0xffff0000, v142
    v_fma_f32 v28, v156, v4, v28
    v_fma_f32 v29, v156, v5, v29
    v_lshlrev_b32 v4, 16, v143
    v_and_b32 v5, 0xffff0000, v143
    v_fma_f32 v30, v156, v4, v30
    v_fma_f32 v31, v156, v5, v31
    v_lshlrev_b32 v4, 16, v144
    v_and_b32 v5, 0xffff0000, v144
    v_fma_f32 v32, v156, v4, v32
    v_fma_f32 v33, v156, v5, v33
    v_lshlrev_b32 v4, 16, v145
    v_and_b32 v5, 0xffff0000, v145
    v_fma_f32 v34, v156, v4, v34
    v_fma_f32 v35, v156, v5, v35
    v_lshlrev_b32 v4, 16, v146
    v_and_b32 v5, 0xffff0000, v146
    v_fma_f32 v36, v156, v4, v36
    v_fma_f32 v37, v156, v5, v37
    v_lshlrev_b32 v4, 16, v147
    v_and_b32 v5, 0xffff0000, v147
    v_fma_f32 v38, v156, v4, v38
    v_fma_f32 v39, v156, v5, v39
L_k2_sk2:
    s_cmp_eq_u32 s13, 3
    s_cbranch_scc0 L_k2_sk3
    v_lshlrev_b32 v4, 16, v140
    v_and_b32 v5, 0xffff0000, v140
    v_fma_f32 v56, v156, v4, v56
    v_fma_f32 v57, v156, v5, v57
    v_lshlrev_b32 v4, 16, v141
    v_and_b32 v5, 0xffff0000, v141
    v_fma_f32 v58, v156, v4, v58
    v_fma_f32 v59, v156, v5, v59
    v_lshlrev_b32 v4, 16, v142
    v_and_b32 v5, 0xffff0000, v142
    v_fma_f32 v60, v156, v4, v60
    v_fma_f32 v61, v156, v5, v61
    v_lshlrev_b32 v4, 16, v143
    v_and_b32 v5, 0xffff0000, v143
    v_fma_f32 v62, v156, v4, v62
    v_fma_f32 v63, v156, v5, v63
    v_lshlrev_b32 v4, 16, v144
    v_and_b32 v5, 0xffff0000, v144
    v_fma_f32 v64, v156, v4, v64
    v_fma_f32 v65, v156, v5, v65
    v_lshlrev_b32 v4, 16, v145
    v_and_b32 v5, 0xffff0000, v145
    v_fma_f32 v66, v156, v4, v66
    v_fma_f32 v67, v156, v5, v67
    v_lshlrev_b32 v4, 16, v146
    v_and_b32 v5, 0xffff0000, v146
    v_fma_f32 v68, v156, v4, v68
    v_fma_f32 v69, v156, v5, v69
    v_lshlrev_b32 v4, 16, v147
    v_and_b32 v5, 0xffff0000, v147
    v_fma_f32 v70, v156, v4, v70
    v_fma_f32 v71, v156, v5, v71
L_k2_sk3:
    v_and_b32 v4, 1, v1
    v_mul_u32_u24 v4, 98304, v4
    v_lshrrev_b32 v5, 1, v1
    v_lshl_add_u32 v4, v5, 10, v4
    v_add_u32 v158, s51, v4
    s_mov_b32 s54, 0x40000
L_k2_pollo0:
    s_mov_b64 exec, 0xffff
    global_load_dword v5, v158, s[4:5] sc1
    s_waitcnt vmcnt(0)
    v_cmp_ne_u32 vcc, -1, v5
    s_mov_b64 exec, -1
    s_nop 1
    s_and_b32 s56, vcc_lo, 0xffff
    s_and_b32 s20, s56, 0xff
    s_cmp_eq_u32 s20, 0xff
    s_cbranch_scc1 L_k2_pollo0d
    s_sub_u32 s54, s54, 1
    s_cmp_lg_u32 s54, 0
    s_cbranch_scc1 L_k2_pollo0
L_k2_pollo0d:
    s_add_u32 s20, s51, 0
    buffer_load_dwordx4 v[72:75], v3, s[44:47], s20 offen sc1
    s_add_u32 s20, s51, 98304
    buffer_load_dwordx4 v[76:79], v3, s[44:47], s20 offen sc1
    s_add_u32 s20, s51, 1024
    buffer_load_dwordx4 v[80:83], v3, s[44:47], s20 offen sc1
    s_add_u32 s20, s51, 99328
    buffer_load_dwordx4 v[84:87], v3, s[44:47], s20 offen sc1
    s_add_u32 s20, s51, 2048
    buffer_load_dwordx4 v[88:91], v3, s[44:47], s20 offen sc1
    s_add_u32 s20, s51, 100352
    buffer_load_dwordx4 v[92:95], v3, s[44:47], s20 offen sc1
    s_add_u32 s20, s51, 3072
    buffer_load_dwordx4 v[96:99], v3, s[44:47], s20 offen sc1
    s_add_u32 s20, s51, 101376
    buffer_load_dwordx4 v[100:103], v3, s[44:47], s20 offen sc1
    s_cmp_eq_u32 s56, 0xffff
    s_cbranch_scc1 L_k2_pollo1d
L_k2_pollo1:
    s_mov_b64 exec, 0xffff
    global_load_dword v5, v158, s[4:5] sc1
    s_waitcnt vmcnt(0)
    v_cmp_ne_u32 vcc, -1, v5
    s_mov_b64 exec, -1
    s_nop 1
    s_and_b32 s56, vcc_lo, 0xffff
    s_cmp_eq_u32 s56, 0xffff
    s_cbranch_scc1 L_k2_pollo1d
    s_sub_u32 s54, s54, 1
    s_cmp_lg_u32 s54, 0
    s_cbranch_scc1 L_k2_pollo1
L_k2_pollo1d:
    s_add_u32 s20, s51, 4096
    buffer_load_dwordx4 v[104:107], v3, s[44:47], s20 offen sc1
    s_add_u32 s20, s51, 102400
    buffer_load_dwordx4 v[108:111], v3, s[44:47], s20 offen sc1
    s_add_u32 s20, s51, 5120
    buffer_load_dwordx4 v[112:115], v3, s[44:47], s20 offen sc1
    s_add_u32 s20, s51, 103424
    buffer_load_dwordx4 v[116:119], v3, s[44:47], s20 offen sc1
    s_add_u32 s20, s51, 6144
    buffer_load_dwordx4 v[120:123], v3, s[44:47], s20 offen sc1
    s_add_u32 s20, s51, 104448
    buffer_load_dwordx4 v[124:127], v3, s[44:47], s20 offen sc1
    s_add_u32 s20, s51, 7168
    buffer_load_dwordx4 v[128:131], v3, s[44:47], s20 offen sc1
    s_add_u32 s20, s51, 105472
    buffer_load_dwordx4 v[132:135], v3, s[44:47], s20 offen sc1
    s_barrier
    ds_read_b128 v[140:143], v157 offset:0
    ds_read_b128 v[144:147], v157 offset:32768
    v_and_b32 v4, 31, v1
    v_lshrrev_b32 v5, 5, v1
    v_lshlrev_b32 v5, 2, v5
    v_and_b32 v6, 7, v4
    v_lshlrev_b32 v4, 8, v4
    s_lshl_b32 s20, s13, 14
    s_add_u32 s20, s20, 65536
    v_add_u32 v4, s20, v4
    v_or_b32 v7, 0, v5
    v_xor_b32 v7, v7, v6
    v_lshl_add_u32 v136, v7, 4, v4
    v_or_b32 v7, 1, v5
    v_xor_b32 v7, v7, v6
    v_lshl_add_u32 v137, v7, 4, v4
    v_or_b32 v7, 2, v5
    v_xor_b32 v7, v7, v6
    v_lshl_add_u32 v138, v7, 4, v4
    v_or_b32 v7, 3, v5
    v_xor_b32 v7, v7, v6
    v_lshl_add_u32 v139, v7, 4, v4
L_k2_ver0:
    s_waitcnt vmcnt(8)
    v_max3_u32 v4, v72, v73, v74
    v_max3_u32 v5, v75, v76, v77
    v_max3_u32 v4, v78, v79, v4
    v_max3_u32 v5, v80, v81, v5
    v_max3_u32 v4, v82, v83, v4
    v_max3_u32 v5, v84, v85, v5
    v_max3_u32 v4, v86, v87, v4
    v_max3_u32 v5, v88, v89, v5
    v_max3_u32 v4, v90, v91, v4
    v_max3_u32 v5, v92, v93, v5
    v_max3_u32 v4, v94, v95, v4
    v_max3_u32 v5, v96, v97, v5
    v_max3_u32 v4, v98, v99, v4
    v_max3_u32 v5, v100, v101, v5
    v_max3_u32 v4, v102, v103, v4
    v_max_u32 v4, v4, v5
    v_cmp_eq_u32 vcc, -1, v4
    s_nop 1
    s_cmp_eq_u64 vcc, 0
    s_cbranch_scc1 L_k2_ver0d
    s_sub_u32 s54, s54, 1
    s_cmp_eq_u32 s54, 0
    s_cbranch_scc1 L_k2_ver0d
    s_waitcnt vmcnt(0)
    s_add_u32 s20, s51, 0
    buffer_load_dwordx4 v[72:75], v3, s[44:47], s20 offen sc1
    s_add_u32 s20, s51, 98304
    buffer_load_dwordx4 v[76:79], v3, s[44:47], s20 offen sc1
    s_add_u32 s20, s51, 1024
    buffer_load_dwordx4 v[80:83], v3, s[44:47], s20 offen sc1
    s_add_u32 s20, s51, 99328
    buffer_load_dwordx4 v[84:87], v3, s[44:47], s20 offen sc1
    s_add_u32 s20, s51, 2048
    buffer_load_dwordx4 v[88:91], v3, s[44:47], s20 offen sc1
    s_add_u32 s20, s51, 100352
    buffer_load_dwordx4 v[92:95], v3, s[44:47], s20 offen sc1
    s_add_u32 s20, s51, 3072
    buffer_load_dwordx4 v[96:99], v3, s[44:47], s20 offen sc1
    s_add_u32 s20, s51, 101376
    buffer_load_dwordx4 v[100:103], v3, s[44:47], s20 offen sc1
    s_waitcnt vmcnt(0)
    s_branch L_k2_ver0
L_k2_ver0d:
    ds_read_b128 v[148:151], v157 offset:1024
    ds_read_b128 v[152:155], v157 offset:33792
    s_waitcnt vmcnt(14) lgkmcnt(2)
    v_mfma_f32_32x32x16_bf16 v[8:23], v[140:143], v[72:75], v[8:23]
    v_mfma_f32_32x32x16_bf16 v[24:39], v[144:147], v[72:75], v[24:39]
    v_mfma_f32_32x32x16_bf16 v[40:55], v[140:143], v[76:79], v[40:55]
    v_mfma_f32_32x32x16_bf16 v[56:71], v[144:147], v[76:79], v[56:71]
    ds_read_b128 v[140:143], v157 offset:2048
    ds_read_b128 v[144:147], v157 offset:34816
    s_waitcnt vmcnt(12) lgkmcnt(2)
    v_mfma_f32_32x32x16_bf16 v[8:23], v[148:151], v[80:83], v[8:23]
    v_mfma_f32_32x32x16_bf16 v[24:39], v[152:155], v[80:83], v[24:39]
    v_mfma_f32_32x32x16_bf16 v[40:55], v[148:151], v[84:87], v[40:55]
    v_mfma_f32_32x32x16_bf16 v[56:71], v[152:155], v[84:87], v[56:71]
    ds_read_b128 v[148:151], v157 offset:3072
    ds_read_b128 v[152:155], v157 offset:35840
    s_waitcnt vmcnt(10) lgkmcnt(2)
    v_mfma_f32_32x32x16_bf16 v[8:23], v[140:143], v[88:91], v[8:23]
    v_mfma_f32_32x32x16_bf16 v[24:39], v[144:147], v[88:91], v[24:39]
    v_mfma_f32_32x32x16_bf16 v[40:55], v[140:143], v[92:95], v[40:55]
    v_mfma_f32_32x32x16_bf16 v[56:71], v[144:147], v[92:95], v[56:71]
    ds_read_b128 v[140:143], v157 offset:4096
    ds_read_b128 v[144:147], v157 offset:36864
    s_waitcnt vmcnt(8) lgkmcnt(2)
    v_mfma_f32_32x32x16_bf16 v[8:23], v[148:151], v[96:99], v[8:23]
    v_mfma_f32_32x32x16_bf16 v[24:39], v[152:155], v[96:99], v[24:39]
    v_mfma_f32_32x32x16_bf16 v[40:55], v[148:151], v[100:103], v[40:55]
    v_mfma_f32_32x32x16_bf16 v[56:71], v[152:155], v[100:103], v[56:71]
L_k2_ver1:
    s_waitcnt vmcnt(0)
    v_max3_u32 v4, v104, v105, v106
    v_max3_u32 v5, v107, v108, v109
    v_max3_u32 v4, v110, v111, v4
    v_max3_u32 v5, v112, v113, v5
    v_max3_u32 v4, v114, v115, v4
    v_max3_u32 v5, v116, v117, v5
    v_max3_u32 v4, v118, v119, v4
    v_max3_u32 v5, v120, v121, v5
    v_max3_u32 v4, v122, v123, v4
    v_max3_u32 v5, v124, v125, v5
    v_max3_u32 v4, v126, v127, v4
    v_max3_u32 v5, v128, v129, v5
    v_max3_u32 v4, v130, v131, v4
    v_max3_u32 v5, v132, v133, v5
    v_max3_u32 v4, v134, v135, v4
    v_max_u32 v4, v4, v5
    v_cmp_eq_u32 vcc, -1, v4
    s_nop 1
    s_cmp_eq_u64 vcc, 0
    s_cbranch_scc1 L_k2_ver1d
    s_sub_u32 s54, s54, 1
    s_cmp_eq_u32 s54, 0
    s_cbranch_scc1 L_k2_ver1d
    s_waitcnt vmcnt(0)
    s_add_u32 s20, s51, 4096
    buffer_load_dwordx4 v[104:107], v3, s[44:47], s20 offen sc1
    s_add_u32 s20, s51, 102400
    buffer_load_dwordx4 v[108:111], v3, s[44:47], s20 offen sc1
    s_add_u32 s20, s51, 5120
    buffer_load_dwordx4 v[112:115], v3, s[44:47], s20 offen sc1
    s_add_u32 s20, s51, 103424
    buffer_load_dwordx4 v[116:119], v3, s[44:47], s20 offen sc1
    s_add_u32 s20, s51, 6144
    buffer_load_dwordx4 v[120:123], v3, s[44:47], s20 offen sc1
    s_add_u32 s20, s51, 104448
    buffer_load_dwordx4 v[124:127], v3, s[44:47], s20 offen sc1
    s_add_u32 s20, s51, 7168
    buffer_load_dwordx4 v[128:131], v3, s[44:47], s20 offen sc1
    s_add_u32 s20, s51, 105472
    buffer_load_dwordx4 v[132:135], v3, s[44:47], s20 offen sc1
    s_waitcnt vmcnt(0)
    s_branch L_k2_ver1
L_k2_ver1d:
    ds_read_b128 v[148:151], v157 offset:5120
    ds_read_b128 v[152:155], v157 offset:37888
    s_waitcnt vmcnt(6) lgkmcnt(2)
    v_mfma_f32_32x32x16_bf16 v[8:23], v[140:143], v[104:107], v[8:23]
    v_mfma_f32_32x32x16_bf16 v[24:39], v[144:147], v[104:107], v[24:39]
    v_mfma_f32_32x32x16_bf16 v[40:55], v[140:143], v[108:111], v[40:55]
    v_mfma_f32_32x32x16_bf16 v[56:71], v[144:147], v[108:111], v[56:71]
    ds_read_b128 v[140:143], v157 offset:6144
    ds_read_b128 v[144:147], v157 offset:38912
    s_waitcnt vmcnt(4) lgkmcnt(2)
    v_mfma_f32_32x32x16_bf16 v[8:23], v[148:151], v[112:115], v[8:23]
    v_mfma_f32_32x32x16_bf16 v[24:39], v[152:155], v[112:115], v[24:39]
    v_mfma_f32_32x32x16_bf16 v[40:55], v[148:151], v[116:119], v[40:55]
    v_mfma_f32_32x32x16_bf16 v[56:71], v[152:155], v[116:119], v[56:71]
    ds_read_b128 v[148:151], v157 offset:7168
    ds_read_b128 v[152:155], v157 offset:39936
    s_waitcnt vmcnt(2) lgkmcnt(2)
    v_mfma_f32_32x32x16_bf16 v[8:23], v[140:143], v[120:123], v[8:23]
    v_mfma_f32_32x32x16_bf16 v[24:39], v[144:147], v[120:123], v[24:39]
    v_mfma_f32_32x32x16_bf16 v[40:55], v[140:143], v[124:127], v[40:55]
    v_mfma_f32_32x32x16_bf16 v[56:71], v[144:147], v[124:127], v[56:71]
    s_waitcnt vmcnt(0) lgkmcnt(0)
    v_mfma_f32_32x32x16_bf16 v[8:23], v[148:151], v[128:131], v[8:23]
    v_mfma_f32_32x32x16_bf16 v[24:39], v[152:155], v[128:131], v[24:39]
    v_mfma_f32_32x32x16_bf16 v[40:55], v[148:151], v[132:135], v[40:55]
    v_mfma_f32_32x32x16_bf16 v[56:71], v[152:155], v[132:135], v[56:71]
    v_lshrrev_b32 v4, 4, v1
    s_lshl_b32 s20, s13, 4
    v_add_u32 v4, s20, v4
    v_and_b32 v5, 15, v1
    v_and_b32 v6, 7, v4
    v_xor_b32 v6, v6, v5
    s_lshl_b32 s20, s48, 6
    v_add_u32 v7, s20, v4
    v_lshlrev_b32 v7, 11, v7
    s_lshl_b32 s21, s49, 8
    v_lshl_add_u32 v73, v5, 4, s21
    v_add_u32 v73, v73, v7
    v_lshlrev_b32 v4, 8, v4
    v_lshl_add_u32 v72, v6, 4, v4
    v_add_u32 v72, 65536, v72
    v_xor_b32 v74, 64, v72
    s_nop 3
    ds_write_b128 v136, v[8:11] offset:0
    ds_write_b128 v137, v[12:15] offset:0
    ds_write_b128 v138, v[16:19] offset:0
    ds_write_b128 v139, v[20:23] offset:0
    ds_write_b128 v136, v[24:27] offset:128
    ds_write_b128 v137, v[28:31] offset:128
    ds_write_b128 v138, v[32:35] offset:128
    ds_write_b128 v139, v[36:39] offset:128
    ds_write_b128 v136, v[40:43] offset:8192
    ds_write_b128 v137, v[44:47] offset:8192
    ds_write_b128 v138, v[48:51] offset:8192
    ds_write_b128 v139, v[52:55] offset:8192
    ds_write_b128 v136, v[56:59] offset:8320
    ds_write_b128 v137, v[60:63] offset:8320
    ds_write_b128 v138, v[64:67] offset:8320
    ds_write_b128 v139, v[68:71] offset:8320
    s_waitcnt lgkmcnt(0)
    s_barrier
    ds_read_b128 v[8:11], v72 offset:0
    ds_read_b128 v[12:15], v72 offset:16384
    ds_read_b128 v[16:19], v72 offset:32768
    ds_read_b128 v[20:23], v72 offset:49152
    ds_read_b128 v[24:27], v74 offset:1024
    ds_read_b128 v[28:31], v74 offset:17408
    ds_read_b128 v[32:35], v74 offset:33792
    ds_read_b128 v[36:39], v74 offset:50176
    ds_read_b128 v[40:43], v72 offset:2048
    ds_read_b128 v[44:47], v72 offset:18432
    ds_read_b128 v[48:51], v72 offset:34816
    ds_read_b128 v[52:55], v72 offset:51200
    ds_read_b128 v[56:59], v74 offset:3072
    ds_read_b128 v[60:63], v74 offset:19456
    ds_read_b128 v[64:67], v74 offset:35840
    ds_read_b128 v[68:71], v74 offset:52224
    s_waitcnt lgkmcnt(12)
    v_add_f32 v8, v8, v12
    v_add_f32 v16, v16, v20
    v_add_f32 v9, v9, v13
    v_add_f32 v17, v17, v21
    v_add_f32 v10, v10, v14
    v_add_f32 v18, v18, v22
    v_add_f32 v11, v11, v15
    v_add_f32 v19, v19, v23
    v_add_f32 v8, v8, v16
    v_add_f32 v9, v9, v17
    v_add_f32 v10, v10, v18
    v_add_f32 v11, v11, v19
    global_store_dwordx4 v73, v[8:11], s[42:43] sc0 sc1
    v_add_u32 v73, 8192, v73
    s_waitcnt lgkmcnt(8)
    v_add_f32 v24, v24, v28
    v_add_f32 v32, v32, v36
    v_add_f32 v25, v25, v29
    v_add_f32 v33, v33, v37
    v_add_f32 v26, v26, v30
    v_add_f32 v34, v34, v38
    v_add_f32 v27, v27, v31
    v_add_f32 v35, v35, v39
    v_add_f32 v24, v24, v32
    v_add_f32 v25, v25, v33
    v_add_f32 v26, v26, v34
    v_add_f32 v27, v27, v35
    global_store_dwordx4 v73, v[24:27], s[42:43] sc0 sc1
    v_add_u32 v73, 8192, v73
    s_waitcnt lgkmcnt(4)
    v_add_f32 v40, v40, v44
    v_add_f32 v48, v48, v52
    v_add_f32 v41, v41, v45
    v_add_f32 v49, v49, v53
    v_add_f32 v42, v42, v46
    v_add_f32 v50, v50, v54
    v_add_f32 v43, v43, v47
    v_add_f32 v51, v51, v55
    v_add_f32 v40, v40, v48
    v_add_f32 v41, v41, v49
    v_add_f32 v42, v42, v50
    v_add_f32 v43, v43, v51
    global_store_dwordx4 v73, v[40:43], s[42:43] sc0 sc1
    v_add_u32 v73, 8192, v73
    s_waitcnt lgkmcnt(0)
    v_add_f32 v56, v56, v60
    v_add_f32 v64, v64, v68
    v_add_f32 v57, v57, v61
    v_add_f32 v65, v65, v69
    v_add_f32 v58, v58, v62
    v_add_f32 v66, v66, v70
    v_add_f32 v59, v59, v63
    v_add_f32 v67, v67, v71
    v_add_f32 v56, v56, v64
    v_add_f32 v57, v57, v65
    v_add_f32 v58, v58, v66
    v_add_f32 v59, v59, v67
    global_store_dwordx4 v73, v[56:59], s[42:43] sc0 sc1
L_k2_end:
    s_endpgm
L_text_end:
.section .rodata,"a"
.p2align 6
.amdhsa_kernel k1_kernel
  .amdhsa_next_free_vgpr 160
  .amdhsa_next_free_sgpr 96
  .amdhsa_accum_offset 160
  .amdhsa_group_segment_fixed_size 0
  .amdhsa_kernarg_size 128
  .amdhsa_user_sgpr_count 2
  .amdhsa_user_sgpr_kernarg_segment_ptr 1
  .amdhsa_system_sgpr_workgroup_id_x 1
  .amdhsa_float_denorm_mode_32 3
.end_amdhsa_kernel
.p2align 6
.amdhsa_kernel k2_kernel
  .amdhsa_next_free_vgpr 160
  .amdhsa_next_free_sgpr 96
  .amdhsa_accum_offset 160
  .amdhsa_group_segment_fixed_size 0
  .amdhsa_kernarg_size 128
  .amdhsa_user_sgpr_count 2
  .amdhsa_user_sgpr_kernarg_segment_ptr 1
  .amdhsa_system_sgpr_workgroup_id_x 1
  .amdhsa_float_denorm_mode_32 3
.end_amdhsa_kernel
```
